```python
import torch

def _softmax(x, axis=-1):
    return torch.softmax(x, dim=axis)
def _gelu(x):
    return torch.nn.functional.gelu(x, approximate="tanh")
def _silu(x):
    return torch.nn.functional.silu(x)
def _sigmoid(x):
    return torch.sigmoid(x)
def _layernorm(x, axis=-1, eps=1e-5):
    m = x.mean(dim=axis, keepdim=True)
    v = x.var(dim=axis, keepdim=True, unbiased=False)
    return (x - m) / torch.sqrt(v + eps)
def _scatter_add(tgt, idx, src, axis=0):
    return tgt.clone().index_add_(axis, idx, src)
def _segment_sum(src, seg, n):
    out = torch.zeros((n,) + src.shape[1:], dtype=src.dtype)
    return out.index_add_(0, seg, src)
def _pad(x, pw):
    flat = tuple(v for pair in reversed(pw) for v in pair)
    return torch.nn.functional.pad(x, flat)

kernel_name = 'standalone__gqa_block_cached__near_ridge'

def setup_inputs():

    _w = (lambda a: (lambda t: t.to(torch.bfloat16) if t.is_floating_point() else t)(torch.as_tensor(a)))
    B, Sq, D = 8, 64, 448
    Hq, Hkv, Sk, Dh = 16, 8, 1024, 256
    assert Hq % Hkv == 0, (Hq, Hkv)
    return {
        "x": _w((lambda *s: torch.randn(*s, dtype=torch.bfloat16) * 0.8)(B, Sq, D)),
        "k_cache": _w((lambda *s: torch.randn(*s, dtype=torch.bfloat16) * 0.8)(B, Hkv, Sk, Dh)),
        "v_cache": _w((lambda *s: torch.randn(*s, dtype=torch.bfloat16) * 0.05)(B, Hkv, Sk, Dh)),
        "wq": _w((lambda *s: torch.randn(*s, dtype=torch.bfloat16) * 0.8)(D, Hq * Dh) * (D ** -0.5)),
        "wo": _w((lambda *s: torch.randn(*s, dtype=torch.bfloat16) * 0.05)(Hq * Dh, D) * ((Hq * Dh) ** -0.5)),
    }

def reference(x, k_cache, v_cache, wq, wo):
    B, Sq, D = x.shape
    Hq, Dh = 16, 256
    Hkv = k_cache.shape[1]
    rep = Hq // Hkv
    q = (lambda x, *d: x.permute(*d))((x @ wq).reshape(B, Sq, Hq, Dh), 0, 2, 1, 3)
    k = (lambda x, n, axis: torch.repeat_interleave(x, n, dim=axis))(k_cache, rep, axis=1)
    v = (lambda x, n, axis: torch.repeat_interleave(x, n, dim=axis))(v_cache, rep, axis=1)
    scores = torch.einsum("bhqd,bhkd->bhqk", q, k) * (Dh ** -0.5)
    p = _softmax(scores, axis=-1)
    o = torch.einsum("bhqk,bhkd->bhqd", p, v)
    return (lambda x, *d: x.permute(*d))(o, 0, 2, 1, 3).reshape(B, Sq, Hq * Dh) @ wo
```

```asm
; @launch grid=(256,1,1) block=(256,1,1) lds=163840
.amdgcn_target "amdgcn-amd-amdhsa--gfx950"
.text
.globl standalone__gqa_block_cached__near_ridge_kernel
.p2align 8
.type standalone__gqa_block_cached__near_ridge_kernel,@function
standalone__gqa_block_cached__near_ridge_kernel:
    s_cmp_ge_u32 s2, 256
    s_cbranch_scc1 L_end
    s_load_dwordx16 s[84:99], s[0:1], 0
    v_lshrrev_b32 v2, 6, v0
    v_and_b32 v226, 63, v0
    v_readfirstlane_b32 s6, v2
    s_and_b32 s3, s2, 7
    s_lshr_b32 s4, s2, 5
    s_bfe_u32 s5, s2, 0x20003
    s_and_b32 s43, s4, 6
    s_mul_i32 s48, s43, 57344
    s_mov_b32 s11, 0x20000
    s_lshl3_add_u32 s49, s3, s5
    s_lshl_b32 s49, s49, 7
    s_bitcmp1_b32 s4, 0
    s_cbranch_scc1 L_h0
L_p1:
    s_mov_b32 s10, 458752
    s_mov_b32 s22, 3670016
    s_mov_b32 s23, 0x20000
    v_lshrrev_b32 v3, 4, v226
    v_and_b32 v4, 15, v226
    s_lshl_b32 s41, s6, 12
    s_lshl_b32 s53, s6, 4
    v_add_u32 v9, s53, v3
    v_lshlrev_b32 v5, 1, v3
    v_xor_b32 v7, v4, v5
    v_lshrrev_b32 v2, 3, v226
    s_lshl_b32 s43, s6, 5
    v_add_u32 v2, s43, v2
    v_mul_u32_u24 v2, 896, v2
    v_and_b32 v6, 7, v226
    v_xor_b32 v6, v6, v3
    v_lshl_add_u32 v10, v6, 4, v2
    v_xor_b32 v11, 64, v10
    v_add_u32 v11, 6144, v11
    v_add_u32 v12, 12288, v10
    v_add_u32 v13, 12288, v11
    v_and_b32 v6, 7, v7
    v_lshlrev_b32 v6, 4, v6
    v_lshrrev_b32 v5, 3, v7
    v_lshl_add_u32 v6, v5, 9, v6
    v_lshl_add_u32 v14, v9, 13, v6
    v_add_u32 v15, 31744, v14
    v_xor_b32 v16, 512, v14
    v_add_u32 v17, 95232, v16
    v_add_u32 v16, 63488, v16
    s_add_u32 s50, s41, 16384
    s_waitcnt lgkmcnt(0)
    s_mov_b64 s[8:9], s[84:85]
    s_mov_b64 s[20:21], s[90:91]
    s_add_u32 m0, s41, 32768
    s_add_u32 s45, s48, 0
    buffer_load_dwordx4 v10, s[8:11], s45 offen offset:0 lds
    buffer_load_dwordx4 v11, s[8:11], s45 offen offset:1024 lds
    buffer_load_dwordx4 v12, s[8:11], s45 offen offset:2048 lds
    buffer_load_dwordx4 v13, s[8:11], s45 offen offset:3072 lds
    s_add_u32 m0, s50, 32768
    s_add_u32 s45, s49, 0
    buffer_load_dwordx4 v14, s[20:23], s45 offen offset:0 lds
    buffer_load_dwordx4 v15, s[20:23], s45 offen offset:1024 lds
    buffer_load_dwordx4 v16, s[20:23], s45 offen offset:2048 lds
    buffer_load_dwordx4 v17, s[20:23], s45 offen offset:3072 lds
    s_branch L_p2
L_h0:
    s_mul_i32 s44, s5, 28672
    s_add_u32 s44, s44, s48
    s_lshl1_add_u32 s43, s43, s5
    s_lshl_b32 s43, s43, 5
    s_add_u32 s43, s43, s3
    s_lshl_b32 s43, s43, 10
    s_cmp_lt_u32 s6, 2
    s_cselect_b32 s51, s44, s43
    s_cselect_b32 s10, 458752, s11
    s_cselect_b32 s44, 896, 0
    s_cselect_b32 s7, 7, 19
    s_cbranch_scc1 L_n0
    s_mov_b32 s10, 3670016
    s_movk_i32 s44, 1024
L_n0:
    v_and_b32 v4, 24, v226
    v_mul_u32_u24 v4, s44, v4
    s_cselect_b32 s44, s44, 128
    v_and_b32 v5, 7, v226
    v_mad_u32_u24 v4, v5, s44, v4
    v_bfe_u32 v17, v0, 5, 2
    v_lshlrev_b32 v5, s7, v17
    v_add_u32 v16, v4, v5
    v_mov_b32 v11, 268435456
    s_waitcnt lgkmcnt(0)
    s_cselect_b32 s8, s84, s90
    s_cselect_b32 s9, s85, s91
    s_lshl_b32 s53, 1, s7
    s_add_u32 s53, s53, s51
    v_cmp_gt_u32 vcc, 1, v17
    s_nop 1
    v_cndmask_b32 v56, v11, v16, vcc
    buffer_load_dword v48, v56, s[8:11], s53 offen
    s_branch L_n1
L_p2:
    s_add_u32 m0, s41, 65536
    s_add_u32 s45, s48, 128
    buffer_load_dwordx4 v10, s[8:11], s45 offen offset:0 lds
    buffer_load_dwordx4 v11, s[8:11], s45 offen offset:1024 lds
    buffer_load_dwordx4 v12, s[8:11], s45 offen offset:2048 lds
    v_bfe_u32 v5, v226, 1, 3
    v_xor_b32 v5, v5, v3
    v_lshlrev_b32 v5, 4, v5
    v_lshl_add_u32 v5, v4, 7, v5
    s_and_b32 s43, s6, 1
    s_lshl_b32 s43, s43, 12
    s_add_u32 s43, s43, 32768
    v_add_u32 v32, s43, v5
    v_xor_b32 v33, 64, v32
    v_bfe_u32 v5, v226, 2, 3
    s_and_b32 s43, s6, 2
    s_lshl_b32 s43, s43, 1
    v_xor_b32 v5, s43, v5
    v_and_b32 v22, 3, v226
    v_lshlrev_b32 v22, 3, v22
    v_lshl_add_u32 v22, v5, 5, v22
    v_bfe_u32 v5, v226, 2, 2
    v_lshl_add_u32 v5, v3, 3, v5
    v_lshl_add_u32 v34, v5, 8, v22
    v_add_u32 v34, 49152, v34
    v_xor_b32 v35, 32, v34
    v_xor_b32 v36, 64, v34
    v_xor_b32 v37, 96, v34
    v_add_u32 v38, 65536, v32
    v_add_u32 v39, 65536, v33
    v_add_u32 v40, 65536, v34
    v_add_u32 v41, 65536, v35
    v_add_u32 v42, 65536, v36
    v_add_u32 v43, 65536, v37
    s_mov_b64 s[12:13], s[86:87]
    s_mov_b32 s14, 33554432
    s_mov_b32 s15, 0x20000
    s_mov_b64 s[16:17], s[88:89]
    s_mov_b32 s18, 33554432
    s_mov_b32 s19, 0x20000
    s_mov_b64 s[24:25], s[92:93]
    s_mov_b32 s26, 3670016
    s_mov_b32 s27, 0x20000
    s_mov_b64 s[28:29], s[94:95]
    s_mov_b32 s30, 458752
    s_mov_b32 s31, 0x20000
    s_mov_b64 s[32:33], s[96:97]
    s_mov_b32 s34, 256
    s_mov_b32 s35, 0x20000
    s_mov_b64 s[36:37], s[98:99]
    s_mov_b32 s38, 268435456
    s_mov_b32 s39, 0x20000
    s_lshr_b32 s43, s2, 3
    s_lshl_b32 s44, s3, 5
    s_add_u32 s44, s44, s43
    s_lshl_b32 s56, s44, 14
    s_lshl3_add_u32 s40, s4, s3
    s_and_b32 s44, s4, 3
    s_xor_b32 s44, s44, s5
    s_lshl2_add_u32 s40, s40, s44
    s_lshl3_add_u32 s40, s40, s4
    s_lshl_b32 s40, s40, 14
    v_lshlrev_b32 v227, 4, v226
    v_add_u32 v234, s41, v227
    s_lshl_b32 s43, s3, 6
    s_add_u32 s43, s43, s4
    s_lshl_b32 s43, s43, 7
    s_add_u32 s43, s43, 33554432
    v_and_b32 v2, 3, v226
    v_xor_b32 v2, s5, v2
    v_lshl_add_u32 v236, v2, 3, s43
    s_andn2_b32 s43, s43, 128
    s_add_u32 s54, s36, s43
    s_addc_u32 s55, s37, 0
    v_mov_b32 v8, 268435456
    v_cmp_eq_u32 vcc, 0, v0
    v_and_b32 v2, 7, v226
    v_lshl_add_u32 v31, v2, 2, s41
    v_cndmask_b32 v235, v8, v236, vcc
    s_cmp_eq_u32 s6, 0
    s_cselect_b32 s46, 1, 0
    s_getreg_b32 s43, hwreg(HW_REG_XCC_ID, 0, 4)
    s_add_u32 s42, s43, 1
    v_mov_b32 v233, s42
    v_and_b32 v2, 31, v226
    v_lshrrev_b32 v8, 5, v226
    s_and_b32 s44, s6, 1
    v_lshl_add_u32 v22, s44, 3, v8
    v_xor_b32 v22, v22, v2
    v_lshlrev_b32 v22, 4, v22
    v_lshl_add_u32 v22, v8, 9, v22
    v_add_u32 v196, s41, v22
    v_xor_b32 v197, 32, v196
    v_xor_b32 v198, 64, v196
    v_xor_b32 v199, 96, v196
    v_bfe_u32 v6, v226, 4, 1
    v_lshlrev_b32 v30, 4, v4
    v_lshl_add_u32 v30, v8, 8, v30
    v_lshl_add_u32 v30, v6, 9, v30
    v_add_u32 v30, s41, v30
    buffer_load_dwordx4 v13, s[8:11], s45 offen offset:3072 lds
    s_add_u32 m0, s50, 65536
    s_add_u32 s45, s49, 524288
    buffer_load_dwordx4 v14, s[20:23], s45 offen offset:0 lds
    buffer_load_dwordx4 v15, s[20:23], s45 offen offset:1024 lds
    buffer_load_dwordx4 v16, s[20:23], s45 offen offset:2048 lds
    buffer_load_dwordx4 v17, s[20:23], s45 offen offset:3072 lds
    s_waitcnt vmcnt(8)
    s_barrier
    ds_read_b128 v[144:147], v32 offset:0
    ds_read_b64_tr_b16 v[128:129], v34 offset:0
    ds_read_b64_tr_b16 v[130:131], v34 offset:1024
    ds_read_b64_tr_b16 v[132:133], v35 offset:0
    ds_read_b64_tr_b16 v[134:135], v35 offset:1024
    ds_read_b128 v[148:151], v32 offset:2048
    ds_read_b64_tr_b16 v[136:137], v36 offset:0
    ds_read_b64_tr_b16 v[138:139], v36 offset:1024
    ds_read_b64_tr_b16 v[140:141], v37 offset:0
    ds_read_b64_tr_b16 v[142:143], v37 offset:1024
    ds_read_b128 v[152:155], v32 offset:8192
    ds_read_b128 v[156:159], v32 offset:10240
    s_waitcnt lgkmcnt(9)
    v_mfma_f32_16x16x32_bf16 v[64:67], v[128:131], v[144:147], 0
    ds_read_b128 v[176:179], v33 offset:0
    s_waitcnt lgkmcnt(8)
    v_mfma_f32_16x16x32_bf16 v[68:71], v[132:135], v[144:147], 0
    s_add_u32 m0, s41, 98304
    s_add_u32 s45, s48, 256
    buffer_load_dwordx4 v10, s[8:11], s45 offen offset:0 lds
    s_waitcnt lgkmcnt(7)
    v_mfma_f32_16x16x32_bf16 v[80:83], v[128:131], v[148:151], 0
    ds_read_b64_tr_b16 v[160:161], v34 offset:8192
    ds_read_b64_tr_b16 v[162:163], v34 offset:9216
    v_mfma_f32_16x16x32_bf16 v[84:87], v[132:135], v[148:151], 0
    s_waitcnt lgkmcnt(7)
    v_mfma_f32_16x16x32_bf16 v[72:75], v[136:139], v[144:147], 0
    ds_read_b64_tr_b16 v[164:165], v35 offset:8192
    ds_read_b64_tr_b16 v[166:167], v35 offset:9216
    s_waitcnt lgkmcnt(7)
    v_mfma_f32_16x16x32_bf16 v[76:79], v[140:143], v[144:147], 0
    buffer_load_dwordx4 v11, s[8:11], s45 offen offset:1024 lds
    v_mfma_f32_16x16x32_bf16 v[88:91], v[136:139], v[148:151], 0
    ds_read_b128 v[180:183], v33 offset:2048
    v_mfma_f32_16x16x32_bf16 v[92:95], v[140:143], v[148:151], 0
    s_waitcnt lgkmcnt(7)
    v_mfma_f32_16x16x32_bf16 v[96:99], v[128:131], v[152:155], 0
    ds_read_b64_tr_b16 v[168:169], v36 offset:8192
    ds_read_b64_tr_b16 v[170:171], v36 offset:9216
    v_mfma_f32_16x16x32_bf16 v[100:103], v[132:135], v[152:155], 0
    buffer_load_dwordx4 v12, s[8:11], s45 offen offset:2048 lds
    v_mfma_f32_16x16x32_bf16 v[104:107], v[136:139], v[152:155], 0
    ds_read_b64_tr_b16 v[172:173], v37 offset:8192
    ds_read_b64_tr_b16 v[174:175], v37 offset:9216
    v_mfma_f32_16x16x32_bf16 v[108:111], v[140:143], v[152:155], 0
    s_waitcnt lgkmcnt(10)
    v_mfma_f32_16x16x32_bf16 v[112:115], v[128:131], v[156:159], 0
    ds_read_b128 v[184:187], v33 offset:8192
    v_mfma_f32_16x16x32_bf16 v[116:119], v[132:135], v[156:159], 0
    buffer_load_dwordx4 v13, s[8:11], s45 offen offset:3072 lds
    v_mfma_f32_16x16x32_bf16 v[120:123], v[136:139], v[156:159], 0
    ds_read_b128 v[188:191], v33 offset:10240
    v_mfma_f32_16x16x32_bf16 v[124:127], v[140:143], v[156:159], 0
    s_waitcnt lgkmcnt(9)
    v_mfma_f32_16x16x32_bf16 v[64:67], v[160:163], v[176:179], v[64:67]
    s_waitcnt vmcnt(4)
    s_barrier
    ds_read_b128 v[144:147], v32 offset:32768
    s_waitcnt lgkmcnt(8)
    v_mfma_f32_16x16x32_bf16 v[68:71], v[164:167], v[176:179], v[68:71]
    s_add_u32 m0, s50, 98304
    s_add_u32 s45, s49, 1048576
    buffer_load_dwordx4 v14, s[20:23], s45 offen offset:0 lds
    s_waitcnt lgkmcnt(7)
    v_mfma_f32_16x16x32_bf16 v[80:83], v[160:163], v[180:183], v[80:83]
    ds_read_b64_tr_b16 v[128:129], v34 offset:32768
    ds_read_b64_tr_b16 v[130:131], v34 offset:33792
    v_mfma_f32_16x16x32_bf16 v[84:87], v[164:167], v[180:183], v[84:87]
    s_waitcnt lgkmcnt(7)
    v_mfma_f32_16x16x32_bf16 v[72:75], v[168:171], v[176:179], v[72:75]
    ds_read_b64_tr_b16 v[132:133], v35 offset:32768
    ds_read_b64_tr_b16 v[134:135], v35 offset:33792
    s_waitcnt lgkmcnt(7)
    v_mfma_f32_16x16x32_bf16 v[76:79], v[172:175], v[176:179], v[76:79]
    buffer_load_dwordx4 v15, s[20:23], s45 offen offset:1024 lds
    v_mfma_f32_16x16x32_bf16 v[88:91], v[168:171], v[180:183], v[88:91]
    ds_read_b128 v[148:151], v32 offset:34816
    v_mfma_f32_16x16x32_bf16 v[92:95], v[172:175], v[180:183], v[92:95]
    s_waitcnt lgkmcnt(7)
    v_mfma_f32_16x16x32_bf16 v[96:99], v[160:163], v[184:187], v[96:99]
    ds_read_b64_tr_b16 v[136:137], v36 offset:32768
    ds_read_b64_tr_b16 v[138:139], v36 offset:33792
    v_mfma_f32_16x16x32_bf16 v[100:103], v[164:167], v[184:187], v[100:103]
    buffer_load_dwordx4 v16, s[20:23], s45 offen offset:2048 lds
    v_mfma_f32_16x16x32_bf16 v[104:107], v[168:171], v[184:187], v[104:107]
    ds_read_b64_tr_b16 v[140:141], v37 offset:32768
    ds_read_b64_tr_b16 v[142:143], v37 offset:33792
    v_mfma_f32_16x16x32_bf16 v[108:111], v[172:175], v[184:187], v[108:111]
    s_waitcnt lgkmcnt(10)
    v_mfma_f32_16x16x32_bf16 v[112:115], v[160:163], v[188:191], v[112:115]
    ds_read_b128 v[152:155], v32 offset:40960
    v_mfma_f32_16x16x32_bf16 v[116:119], v[164:167], v[188:191], v[116:119]
    buffer_load_dwordx4 v17, s[20:23], s45 offen offset:3072 lds
    v_mfma_f32_16x16x32_bf16 v[120:123], v[168:171], v[188:191], v[120:123]
    ds_read_b128 v[156:159], v32 offset:43008
    v_mfma_f32_16x16x32_bf16 v[124:127], v[172:175], v[188:191], v[124:127]
    s_waitcnt lgkmcnt(9)
    v_mfma_f32_16x16x32_bf16 v[64:67], v[128:131], v[144:147], v[64:67]
    ds_read_b128 v[176:179], v33 offset:32768
    s_waitcnt lgkmcnt(8)
    v_mfma_f32_16x16x32_bf16 v[68:71], v[132:135], v[144:147], v[68:71]
    s_add_u32 m0, s41, 131072
    s_add_u32 s45, s48, 384
    buffer_load_dwordx4 v10, s[8:11], s45 offen offset:0 lds
    s_waitcnt lgkmcnt(7)
    v_mfma_f32_16x16x32_bf16 v[80:83], v[128:131], v[148:151], v[80:83]
    ds_read_b64_tr_b16 v[160:161], v34 offset:40960
    ds_read_b64_tr_b16 v[162:163], v34 offset:41984
    v_mfma_f32_16x16x32_bf16 v[84:87], v[132:135], v[148:151], v[84:87]
    s_waitcnt lgkmcnt(7)
    v_mfma_f32_16x16x32_bf16 v[72:75], v[136:139], v[144:147], v[72:75]
    ds_read_b64_tr_b16 v[164:165], v35 offset:40960
    ds_read_b64_tr_b16 v[166:167], v35 offset:41984
    s_waitcnt lgkmcnt(7)
    v_mfma_f32_16x16x32_bf16 v[76:79], v[140:143], v[144:147], v[76:79]
    buffer_load_dwordx4 v11, s[8:11], s45 offen offset:1024 lds
    v_mfma_f32_16x16x32_bf16 v[88:91], v[136:139], v[148:151], v[88:91]
    ds_read_b128 v[180:183], v33 offset:34816
    v_mfma_f32_16x16x32_bf16 v[92:95], v[140:143], v[148:151], v[92:95]
    s_waitcnt lgkmcnt(7)
    v_mfma_f32_16x16x32_bf16 v[96:99], v[128:131], v[152:155], v[96:99]
    ds_read_b64_tr_b16 v[168:169], v36 offset:40960
    ds_read_b64_tr_b16 v[170:171], v36 offset:41984
    v_mfma_f32_16x16x32_bf16 v[100:103], v[132:135], v[152:155], v[100:103]
    buffer_load_dwordx4 v12, s[8:11], s45 offen offset:2048 lds
    v_mfma_f32_16x16x32_bf16 v[104:107], v[136:139], v[152:155], v[104:107]
    ds_read_b64_tr_b16 v[172:173], v37 offset:40960
    ds_read_b64_tr_b16 v[174:175], v37 offset:41984
    v_mfma_f32_16x16x32_bf16 v[108:111], v[140:143], v[152:155], v[108:111]
    s_waitcnt lgkmcnt(10)
    v_mfma_f32_16x16x32_bf16 v[112:115], v[128:131], v[156:159], v[112:115]
    ds_read_b128 v[184:187], v33 offset:40960
    v_mfma_f32_16x16x32_bf16 v[116:119], v[132:135], v[156:159], v[116:119]
    buffer_load_dwordx4 v13, s[8:11], s45 offen offset:3072 lds
    v_mfma_f32_16x16x32_bf16 v[120:123], v[136:139], v[156:159], v[120:123]
    ds_read_b128 v[188:191], v33 offset:43008
    v_mfma_f32_16x16x32_bf16 v[124:127], v[140:143], v[156:159], v[124:127]
    s_waitcnt lgkmcnt(9)
    v_mfma_f32_16x16x32_bf16 v[64:67], v[160:163], v[176:179], v[64:67]
    s_waitcnt vmcnt(4)
    s_barrier
    ds_read_b128 v[144:147], v38 offset:0
    s_waitcnt lgkmcnt(8)
    v_mfma_f32_16x16x32_bf16 v[68:71], v[164:167], v[176:179], v[68:71]
    s_add_u32 m0, s50, 131072
    s_add_u32 s45, s49, 1572864
    buffer_load_dwordx4 v14, s[20:23], s45 offen offset:0 lds
    s_waitcnt lgkmcnt(7)
    v_mfma_f32_16x16x32_bf16 v[80:83], v[160:163], v[180:183], v[80:83]
    ds_read_b64_tr_b16 v[128:129], v40 offset:0
    ds_read_b64_tr_b16 v[130:131], v40 offset:1024
    v_mfma_f32_16x16x32_bf16 v[84:87], v[164:167], v[180:183], v[84:87]
    s_waitcnt lgkmcnt(7)
    v_mfma_f32_16x16x32_bf16 v[72:75], v[168:171], v[176:179], v[72:75]
    ds_read_b64_tr_b16 v[132:133], v41 offset:0
    ds_read_b64_tr_b16 v[134:135], v41 offset:1024
    s_waitcnt lgkmcnt(7)
    v_mfma_f32_16x16x32_bf16 v[76:79], v[172:175], v[176:179], v[76:79]
    buffer_load_dwordx4 v15, s[20:23], s45 offen offset:1024 lds
    v_mfma_f32_16x16x32_bf16 v[88:91], v[168:171], v[180:183], v[88:91]
    ds_read_b128 v[148:151], v38 offset:2048
    v_mfma_f32_16x16x32_bf16 v[92:95], v[172:175], v[180:183], v[92:95]
    s_waitcnt lgkmcnt(7)
    v_mfma_f32_16x16x32_bf16 v[96:99], v[160:163], v[184:187], v[96:99]
    ds_read_b64_tr_b16 v[136:137], v42 offset:0
    ds_read_b64_tr_b16 v[138:139], v42 offset:1024
    v_mfma_f32_16x16x32_bf16 v[100:103], v[164:167], v[184:187], v[100:103]
    buffer_load_dwordx4 v16, s[20:23], s45 offen offset:2048 lds
    v_mfma_f32_16x16x32_bf16 v[104:107], v[168:171], v[184:187], v[104:107]
    ds_read_b64_tr_b16 v[140:141], v43 offset:0
    ds_read_b64_tr_b16 v[142:143], v43 offset:1024
    v_mfma_f32_16x16x32_bf16 v[108:111], v[172:175], v[184:187], v[108:111]
    s_waitcnt lgkmcnt(10)
    v_mfma_f32_16x16x32_bf16 v[112:115], v[160:163], v[188:191], v[112:115]
    ds_read_b128 v[152:155], v38 offset:8192
    v_mfma_f32_16x16x32_bf16 v[116:119], v[164:167], v[188:191], v[116:119]
    buffer_load_dwordx4 v17, s[20:23], s45 offen offset:3072 lds
    v_mfma_f32_16x16x32_bf16 v[120:123], v[168:171], v[188:191], v[120:123]
    ds_read_b128 v[156:159], v38 offset:10240
    v_mfma_f32_16x16x32_bf16 v[124:127], v[172:175], v[188:191], v[124:127]
    s_waitcnt lgkmcnt(9)
    v_mfma_f32_16x16x32_bf16 v[64:67], v[128:131], v[144:147], v[64:67]
    ds_read_b128 v[176:179], v39 offset:0
    s_waitcnt lgkmcnt(8)
    v_mfma_f32_16x16x32_bf16 v[68:71], v[132:135], v[144:147], v[68:71]
    s_add_u32 m0, s41, 32768
    s_add_u32 s45, s48, 512
    buffer_load_dwordx4 v10, s[8:11], s45 offen offset:0 lds
    s_waitcnt lgkmcnt(7)
    v_mfma_f32_16x16x32_bf16 v[80:83], v[128:131], v[148:151], v[80:83]
    ds_read_b64_tr_b16 v[160:161], v40 offset:8192
    ds_read_b64_tr_b16 v[162:163], v40 offset:9216
    v_mfma_f32_16x16x32_bf16 v[84:87], v[132:135], v[148:151], v[84:87]
    s_waitcnt lgkmcnt(7)
    v_mfma_f32_16x16x32_bf16 v[72:75], v[136:139], v[144:147], v[72:75]
    ds_read_b64_tr_b16 v[164:165], v41 offset:8192
    ds_read_b64_tr_b16 v[166:167], v41 offset:9216
    s_waitcnt lgkmcnt(7)
    v_mfma_f32_16x16x32_bf16 v[76:79], v[140:143], v[144:147], v[76:79]
    buffer_load_dwordx4 v11, s[8:11], s45 offen offset:1024 lds
    v_mfma_f32_16x16x32_bf16 v[88:91], v[136:139], v[148:151], v[88:91]
    ds_read_b128 v[180:183], v39 offset:2048
    v_mfma_f32_16x16x32_bf16 v[92:95], v[140:143], v[148:151], v[92:95]
    s_waitcnt lgkmcnt(7)
    v_mfma_f32_16x16x32_bf16 v[96:99], v[128:131], v[152:155], v[96:99]
    ds_read_b64_tr_b16 v[168:169], v42 offset:8192
    ds_read_b64_tr_b16 v[170:171], v42 offset:9216
    v_mfma_f32_16x16x32_bf16 v[100:103], v[132:135], v[152:155], v[100:103]
    buffer_load_dwordx4 v12, s[8:11], s45 offen offset:2048 lds
    v_mfma_f32_16x16x32_bf16 v[104:107], v[136:139], v[152:155], v[104:107]
    ds_read_b64_tr_b16 v[172:173], v43 offset:8192
    ds_read_b64_tr_b16 v[174:175], v43 offset:9216
    v_mfma_f32_16x16x32_bf16 v[108:111], v[140:143], v[152:155], v[108:111]
    s_waitcnt lgkmcnt(10)
    v_mfma_f32_16x16x32_bf16 v[112:115], v[128:131], v[156:159], v[112:115]
    ds_read_b128 v[184:187], v39 offset:8192
    v_mfma_f32_16x16x32_bf16 v[116:119], v[132:135], v[156:159], v[116:119]
    buffer_load_dwordx4 v13, s[8:11], s45 offen offset:3072 lds
    v_mfma_f32_16x16x32_bf16 v[120:123], v[136:139], v[156:159], v[120:123]
    ds_read_b128 v[188:191], v39 offset:10240
    v_mfma_f32_16x16x32_bf16 v[124:127], v[140:143], v[156:159], v[124:127]
    s_waitcnt lgkmcnt(9)
    v_mfma_f32_16x16x32_bf16 v[64:67], v[160:163], v[176:179], v[64:67]
    s_waitcnt vmcnt(4)
    s_barrier
    ds_read_b128 v[144:147], v38 offset:32768
    s_waitcnt lgkmcnt(8)
    v_mfma_f32_16x16x32_bf16 v[68:71], v[164:167], v[176:179], v[68:71]
    s_add_u32 m0, s50, 32768
    s_add_u32 s45, s49, 2097152
    buffer_load_dwordx4 v14, s[20:23], s45 offen offset:0 lds
    s_waitcnt lgkmcnt(7)
    v_mfma_f32_16x16x32_bf16 v[80:83], v[160:163], v[180:183], v[80:83]
    ds_read_b64_tr_b16 v[128:129], v40 offset:32768
    ds_read_b64_tr_b16 v[130:131], v40 offset:33792
    v_mfma_f32_16x16x32_bf16 v[84:87], v[164:167], v[180:183], v[84:87]
    s_waitcnt lgkmcnt(7)
    v_mfma_f32_16x16x32_bf16 v[72:75], v[168:171], v[176:179], v[72:75]
    ds_read_b64_tr_b16 v[132:133], v41 offset:32768
    ds_read_b64_tr_b16 v[134:135], v41 offset:33792
    s_waitcnt lgkmcnt(7)
    v_mfma_f32_16x16x32_bf16 v[76:79], v[172:175], v[176:179], v[76:79]
    buffer_load_dwordx4 v15, s[20:23], s45 offen offset:1024 lds
    v_mfma_f32_16x16x32_bf16 v[88:91], v[168:171], v[180:183], v[88:91]
    ds_read_b128 v[148:151], v38 offset:34816
    v_mfma_f32_16x16x32_bf16 v[92:95], v[172:175], v[180:183], v[92:95]
    s_waitcnt lgkmcnt(7)
    v_mfma_f32_16x16x32_bf16 v[96:99], v[160:163], v[184:187], v[96:99]
    ds_read_b64_tr_b16 v[136:137], v42 offset:32768
    ds_read_b64_tr_b16 v[138:139], v42 offset:33792
    v_mfma_f32_16x16x32_bf16 v[100:103], v[164:167], v[184:187], v[100:103]
    buffer_load_dwordx4 v16, s[20:23], s45 offen offset:2048 lds
    v_mfma_f32_16x16x32_bf16 v[104:107], v[168:171], v[184:187], v[104:107]
    ds_read_b64_tr_b16 v[140:141], v43 offset:32768
    ds_read_b64_tr_b16 v[142:143], v43 offset:33792
    v_mfma_f32_16x16x32_bf16 v[108:111], v[172:175], v[184:187], v[108:111]
    s_waitcnt lgkmcnt(10)
    v_mfma_f32_16x16x32_bf16 v[112:115], v[160:163], v[188:191], v[112:115]
    ds_read_b128 v[152:155], v38 offset:40960
    v_mfma_f32_16x16x32_bf16 v[116:119], v[164:167], v[188:191], v[116:119]
    buffer_load_dwordx4 v17, s[20:23], s45 offen offset:3072 lds
    v_mfma_f32_16x16x32_bf16 v[120:123], v[168:171], v[188:191], v[120:123]
    ds_read_b128 v[156:159], v38 offset:43008
    v_mfma_f32_16x16x32_bf16 v[124:127], v[172:175], v[188:191], v[124:127]
    s_waitcnt lgkmcnt(9)
    v_mfma_f32_16x16x32_bf16 v[64:67], v[128:131], v[144:147], v[64:67]
    ds_read_b128 v[176:179], v39 offset:32768
    s_waitcnt lgkmcnt(8)
    v_mfma_f32_16x16x32_bf16 v[68:71], v[132:135], v[144:147], v[68:71]
    s_add_u32 m0, s41, 65536
    s_add_u32 s45, s48, 640
    buffer_load_dwordx4 v10, s[8:11], s45 offen offset:0 lds
    s_waitcnt lgkmcnt(7)
    v_mfma_f32_16x16x32_bf16 v[80:83], v[128:131], v[148:151], v[80:83]
    ds_read_b64_tr_b16 v[160:161], v40 offset:40960
    ds_read_b64_tr_b16 v[162:163], v40 offset:41984
    v_mfma_f32_16x16x32_bf16 v[84:87], v[132:135], v[148:151], v[84:87]
    s_waitcnt lgkmcnt(7)
    v_mfma_f32_16x16x32_bf16 v[72:75], v[136:139], v[144:147], v[72:75]
    ds_read_b64_tr_b16 v[164:165], v41 offset:40960
    ds_read_b64_tr_b16 v[166:167], v41 offset:41984
    s_waitcnt lgkmcnt(7)
    v_mfma_f32_16x16x32_bf16 v[76:79], v[140:143], v[144:147], v[76:79]
    buffer_load_dwordx4 v11, s[8:11], s45 offen offset:1024 lds
    v_mfma_f32_16x16x32_bf16 v[88:91], v[136:139], v[148:151], v[88:91]
    ds_read_b128 v[180:183], v39 offset:34816
    v_mfma_f32_16x16x32_bf16 v[92:95], v[140:143], v[148:151], v[92:95]
    s_waitcnt lgkmcnt(7)
    v_mfma_f32_16x16x32_bf16 v[96:99], v[128:131], v[152:155], v[96:99]
    ds_read_b64_tr_b16 v[168:169], v42 offset:40960
    ds_read_b64_tr_b16 v[170:171], v42 offset:41984
    v_mfma_f32_16x16x32_bf16 v[100:103], v[132:135], v[152:155], v[100:103]
    buffer_load_dwordx4 v12, s[8:11], s45 offen offset:2048 lds
    v_mfma_f32_16x16x32_bf16 v[104:107], v[136:139], v[152:155], v[104:107]
    ds_read_b64_tr_b16 v[172:173], v43 offset:40960
    ds_read_b64_tr_b16 v[174:175], v43 offset:41984
    v_mfma_f32_16x16x32_bf16 v[108:111], v[140:143], v[152:155], v[108:111]
    s_waitcnt lgkmcnt(10)
    v_mfma_f32_16x16x32_bf16 v[112:115], v[128:131], v[156:159], v[112:115]
    ds_read_b128 v[184:187], v39 offset:40960
    v_mfma_f32_16x16x32_bf16 v[116:119], v[132:135], v[156:159], v[116:119]
    buffer_load_dwordx4 v13, s[8:11], s45 offen offset:3072 lds
    v_mfma_f32_16x16x32_bf16 v[120:123], v[136:139], v[156:159], v[120:123]
    ds_read_b128 v[188:191], v39 offset:43008
    v_mfma_f32_16x16x32_bf16 v[124:127], v[140:143], v[156:159], v[124:127]
    s_waitcnt lgkmcnt(9)
    v_mfma_f32_16x16x32_bf16 v[64:67], v[160:163], v[176:179], v[64:67]
    s_waitcnt vmcnt(4)
    s_barrier
    ds_read_b128 v[144:147], v32 offset:0
    s_waitcnt lgkmcnt(8)
    v_mfma_f32_16x16x32_bf16 v[68:71], v[164:167], v[176:179], v[68:71]
    s_add_u32 m0, s50, 65536
    s_add_u32 s45, s49, 2621440
    buffer_load_dwordx4 v14, s[20:23], s45 offen offset:0 lds
    s_waitcnt lgkmcnt(7)
    v_mfma_f32_16x16x32_bf16 v[80:83], v[160:163], v[180:183], v[80:83]
    ds_read_b64_tr_b16 v[128:129], v34 offset:0
    ds_read_b64_tr_b16 v[130:131], v34 offset:1024
    v_mfma_f32_16x16x32_bf16 v[84:87], v[164:167], v[180:183], v[84:87]
    s_waitcnt lgkmcnt(7)
    v_mfma_f32_16x16x32_bf16 v[72:75], v[168:171], v[176:179], v[72:75]
    ds_read_b64_tr_b16 v[132:133], v35 offset:0
    ds_read_b64_tr_b16 v[134:135], v35 offset:1024
    s_waitcnt lgkmcnt(7)
    v_mfma_f32_16x16x32_bf16 v[76:79], v[172:175], v[176:179], v[76:79]
    buffer_load_dwordx4 v15, s[20:23], s45 offen offset:1024 lds
    v_mfma_f32_16x16x32_bf16 v[88:91], v[168:171], v[180:183], v[88:91]
    ds_read_b128 v[148:151], v32 offset:2048
    v_mfma_f32_16x16x32_bf16 v[92:95], v[172:175], v[180:183], v[92:95]
    s_waitcnt lgkmcnt(7)
    v_mfma_f32_16x16x32_bf16 v[96:99], v[160:163], v[184:187], v[96:99]
    ds_read_b64_tr_b16 v[136:137], v36 offset:0
    ds_read_b64_tr_b16 v[138:139], v36 offset:1024
    v_mfma_f32_16x16x32_bf16 v[100:103], v[164:167], v[184:187], v[100:103]
    buffer_load_dwordx4 v16, s[20:23], s45 offen offset:2048 lds
    v_mfma_f32_16x16x32_bf16 v[104:107], v[168:171], v[184:187], v[104:107]
    ds_read_b64_tr_b16 v[140:141], v37 offset:0
    ds_read_b64_tr_b16 v[142:143], v37 offset:1024
    v_mfma_f32_16x16x32_bf16 v[108:111], v[172:175], v[184:187], v[108:111]
    s_waitcnt lgkmcnt(10)
    v_mfma_f32_16x16x32_bf16 v[112:115], v[160:163], v[188:191], v[112:115]
    ds_read_b128 v[152:155], v32 offset:8192
    v_mfma_f32_16x16x32_bf16 v[116:119], v[164:167], v[188:191], v[116:119]
    buffer_load_dwordx4 v17, s[20:23], s45 offen offset:3072 lds
    v_mfma_f32_16x16x32_bf16 v[120:123], v[168:171], v[188:191], v[120:123]
    ds_read_b128 v[156:159], v32 offset:10240
    v_mfma_f32_16x16x32_bf16 v[124:127], v[172:175], v[188:191], v[124:127]
    s_waitcnt lgkmcnt(9)
    v_mfma_f32_16x16x32_bf16 v[64:67], v[128:131], v[144:147], v[64:67]
    ds_read_b128 v[176:179], v33 offset:0
    s_waitcnt lgkmcnt(8)
    v_mfma_f32_16x16x32_bf16 v[68:71], v[132:135], v[144:147], v[68:71]
    s_add_u32 m0, s41, 98304
    s_add_u32 s45, s48, 768
    buffer_load_dwordx4 v10, s[8:11], s45 offen offset:0 lds
    s_waitcnt lgkmcnt(7)
    v_mfma_f32_16x16x32_bf16 v[80:83], v[128:131], v[148:151], v[80:83]
    ds_read_b64_tr_b16 v[160:161], v34 offset:8192
    ds_read_b64_tr_b16 v[162:163], v34 offset:9216
    v_mfma_f32_16x16x32_bf16 v[84:87], v[132:135], v[148:151], v[84:87]
    s_waitcnt lgkmcnt(7)
    v_mfma_f32_16x16x32_bf16 v[72:75], v[136:139], v[144:147], v[72:75]
    ds_read_b64_tr_b16 v[164:165], v35 offset:8192
    ds_read_b64_tr_b16 v[166:167], v35 offset:9216
    s_waitcnt lgkmcnt(7)
    v_mfma_f32_16x16x32_bf16 v[76:79], v[140:143], v[144:147], v[76:79]
    buffer_load_dwordx4 v11, s[8:11], s45 offen offset:1024 lds
    v_mfma_f32_16x16x32_bf16 v[88:91], v[136:139], v[148:151], v[88:91]
    ds_read_b128 v[180:183], v33 offset:2048
    v_mfma_f32_16x16x32_bf16 v[92:95], v[140:143], v[148:151], v[92:95]
    s_waitcnt lgkmcnt(7)
    v_mfma_f32_16x16x32_bf16 v[96:99], v[128:131], v[152:155], v[96:99]
    ds_read_b64_tr_b16 v[168:169], v36 offset:8192
    ds_read_b64_tr_b16 v[170:171], v36 offset:9216
    v_mfma_f32_16x16x32_bf16 v[100:103], v[132:135], v[152:155], v[100:103]
    buffer_load_dwordx4 v12, s[8:11], s45 offen offset:2048 lds
    v_mfma_f32_16x16x32_bf16 v[104:107], v[136:139], v[152:155], v[104:107]
    ds_read_b64_tr_b16 v[172:173], v37 offset:8192
    ds_read_b64_tr_b16 v[174:175], v37 offset:9216
    v_mfma_f32_16x16x32_bf16 v[108:111], v[140:143], v[152:155], v[108:111]
    s_waitcnt lgkmcnt(10)
    v_mfma_f32_16x16x32_bf16 v[112:115], v[128:131], v[156:159], v[112:115]
    ds_read_b128 v[184:187], v33 offset:8192
    v_mfma_f32_16x16x32_bf16 v[116:119], v[132:135], v[156:159], v[116:119]
    buffer_load_dwordx4 v13, s[8:11], s45 offen offset:3072 lds
    v_mfma_f32_16x16x32_bf16 v[120:123], v[136:139], v[156:159], v[120:123]
    ds_read_b128 v[188:191], v33 offset:10240
    v_mfma_f32_16x16x32_bf16 v[124:127], v[140:143], v[156:159], v[124:127]
    s_waitcnt lgkmcnt(9)
    v_mfma_f32_16x16x32_bf16 v[64:67], v[160:163], v[176:179], v[64:67]
    s_waitcnt vmcnt(4)
    s_barrier
    ds_read_b128 v[144:147], v32 offset:32768
    s_waitcnt lgkmcnt(8)
    v_mfma_f32_16x16x32_bf16 v[68:71], v[164:167], v[176:179], v[68:71]
    s_add_u32 m0, s50, 98304
    s_add_u32 s45, s49, 3145728
    buffer_load_dwordx4 v14, s[20:23], s45 offen offset:0 lds
    s_waitcnt lgkmcnt(7)
    v_mfma_f32_16x16x32_bf16 v[80:83], v[160:163], v[180:183], v[80:83]
    ds_read_b64_tr_b16 v[128:129], v34 offset:32768
    ds_read_b64_tr_b16 v[130:131], v34 offset:33792
    v_mfma_f32_16x16x32_bf16 v[84:87], v[164:167], v[180:183], v[84:87]
    s_waitcnt lgkmcnt(7)
    v_mfma_f32_16x16x32_bf16 v[72:75], v[168:171], v[176:179], v[72:75]
    ds_read_b64_tr_b16 v[132:133], v35 offset:32768
    ds_read_b64_tr_b16 v[134:135], v35 offset:33792
    s_waitcnt lgkmcnt(7)
    v_mfma_f32_16x16x32_bf16 v[76:79], v[172:175], v[176:179], v[76:79]
    buffer_load_dwordx4 v15, s[20:23], s45 offen offset:1024 lds
    v_mfma_f32_16x16x32_bf16 v[88:91], v[168:171], v[180:183], v[88:91]
    ds_read_b128 v[148:151], v32 offset:34816
    v_mfma_f32_16x16x32_bf16 v[92:95], v[172:175], v[180:183], v[92:95]
    s_waitcnt lgkmcnt(7)
    v_mfma_f32_16x16x32_bf16 v[96:99], v[160:163], v[184:187], v[96:99]
    ds_read_b64_tr_b16 v[136:137], v36 offset:32768
    ds_read_b64_tr_b16 v[138:139], v36 offset:33792
    v_mfma_f32_16x16x32_bf16 v[100:103], v[164:167], v[184:187], v[100:103]
    buffer_load_dwordx4 v16, s[20:23], s45 offen offset:2048 lds
    v_mfma_f32_16x16x32_bf16 v[104:107], v[168:171], v[184:187], v[104:107]
    ds_read_b64_tr_b16 v[140:141], v37 offset:32768
    ds_read_b64_tr_b16 v[142:143], v37 offset:33792
    v_mfma_f32_16x16x32_bf16 v[108:111], v[172:175], v[184:187], v[108:111]
    s_waitcnt lgkmcnt(10)
    v_mfma_f32_16x16x32_bf16 v[112:115], v[160:163], v[188:191], v[112:115]
    ds_read_b128 v[152:155], v32 offset:40960
    v_mfma_f32_16x16x32_bf16 v[116:119], v[164:167], v[188:191], v[116:119]
    buffer_load_dwordx4 v17, s[20:23], s45 offen offset:3072 lds
    v_mfma_f32_16x16x32_bf16 v[120:123], v[168:171], v[188:191], v[120:123]
    ds_read_b128 v[156:159], v32 offset:43008
    v_mfma_f32_16x16x32_bf16 v[124:127], v[172:175], v[188:191], v[124:127]
    s_waitcnt lgkmcnt(9)
    v_mfma_f32_16x16x32_bf16 v[64:67], v[128:131], v[144:147], v[64:67]
    ds_read_b128 v[176:179], v33 offset:32768
    s_add_u32 s43, s56, 65536
    s_waitcnt lgkmcnt(8)
    v_mfma_f32_16x16x32_bf16 v[68:71], v[132:135], v[144:147], v[68:71]
    s_mov_b32 s52, 0x3db8aa3b
    s_waitcnt lgkmcnt(7)
    v_mfma_f32_16x16x32_bf16 v[80:83], v[128:131], v[148:151], v[80:83]
    ds_read_b64_tr_b16 v[160:161], v34 offset:40960
    ds_read_b64_tr_b16 v[162:163], v34 offset:41984
    v_mfma_f32_16x16x32_bf16 v[84:87], v[132:135], v[148:151], v[84:87]
    buffer_load_dword v237, v31, s[32:35], 0 offen sc1
    s_waitcnt lgkmcnt(7)
    v_mfma_f32_16x16x32_bf16 v[72:75], v[136:139], v[144:147], v[72:75]
    ds_read_b64_tr_b16 v[164:165], v35 offset:40960
    ds_read_b64_tr_b16 v[166:167], v35 offset:41984
    s_waitcnt lgkmcnt(7)
    v_mfma_f32_16x16x32_bf16 v[76:79], v[140:143], v[144:147], v[76:79]
    s_add_u32 m0, s41, 0
    s_xor_b32 s45, s40, 0
    buffer_load_dwordx4 v196, s[12:15], s45 offen offset:0 nt lds
    v_mfma_f32_16x16x32_bf16 v[88:91], v[136:139], v[148:151], v[88:91]
    ds_read_b128 v[180:183], v33 offset:34816
    v_mfma_f32_16x16x32_bf16 v[92:95], v[140:143], v[148:151], v[92:95]
    s_waitcnt lgkmcnt(7)
    v_mfma_f32_16x16x32_bf16 v[96:99], v[128:131], v[152:155], v[96:99]
    ds_read_b64_tr_b16 v[168:169], v36 offset:40960
    ds_read_b64_tr_b16 v[170:171], v36 offset:41984
    v_mfma_f32_16x16x32_bf16 v[100:103], v[132:135], v[152:155], v[100:103]
    buffer_load_dwordx4 v197, s[12:15], s45 offen offset:1024 nt lds
    v_mfma_f32_16x16x32_bf16 v[104:107], v[136:139], v[152:155], v[104:107]
    ds_read_b64_tr_b16 v[172:173], v37 offset:40960
    ds_read_b64_tr_b16 v[174:175], v37 offset:41984
    v_mfma_f32_16x16x32_bf16 v[108:111], v[140:143], v[152:155], v[108:111]
    s_waitcnt lgkmcnt(10)
    v_mfma_f32_16x16x32_bf16 v[112:115], v[128:131], v[156:159], v[112:115]
    ds_read_b128 v[184:187], v33 offset:40960
    v_mfma_f32_16x16x32_bf16 v[116:119], v[132:135], v[156:159], v[116:119]
    buffer_load_dwordx4 v198, s[12:15], s45 offen offset:2048 nt lds
    v_mfma_f32_16x16x32_bf16 v[120:123], v[136:139], v[156:159], v[120:123]
    ds_read_b128 v[188:191], v33 offset:43008
    v_mfma_f32_16x16x32_bf16 v[124:127], v[140:143], v[156:159], v[124:127]
    s_waitcnt lgkmcnt(9)
    v_mfma_f32_16x16x32_bf16 v[64:67], v[160:163], v[176:179], v[64:67]
    s_waitcnt vmcnt(4)
    s_barrier
    ds_read_b128 v[144:147], v38 offset:0
    s_waitcnt lgkmcnt(8)
    v_mfma_f32_16x16x32_bf16 v[68:71], v[164:167], v[176:179], v[68:71]
    buffer_load_dwordx4 v199, s[12:15], s45 offen offset:3072 nt lds
    s_waitcnt lgkmcnt(7)
    v_mfma_f32_16x16x32_bf16 v[80:83], v[160:163], v[180:183], v[80:83]
    ds_read_b128 a[16:19], v39 offset:0
    v_mfma_f32_16x16x32_bf16 v[84:87], v[164:167], v[180:183], v[84:87]
    s_waitcnt lgkmcnt(6)
    v_mfma_f32_16x16x32_bf16 v[72:75], v[168:171], v[176:179], v[72:75]
    ds_read_b64_tr_b16 v[128:129], v40 offset:0
    ds_read_b64_tr_b16 v[130:131], v40 offset:1024
    s_waitcnt lgkmcnt(6)
    v_mfma_f32_16x16x32_bf16 v[76:79], v[172:175], v[176:179], v[76:79]
    s_add_u32 m0, s41, 16384
    s_xor_b32 s45, s40, 16384
    buffer_load_dwordx4 v196, s[12:15], s45 offen offset:0 nt lds
    v_mfma_f32_16x16x32_bf16 v[88:91], v[168:171], v[180:183], v[88:91]
    ds_read_b64_tr_b16 a[0:1], v40 offset:8192
    ds_read_b64_tr_b16 a[2:3], v40 offset:9216
    v_mfma_f32_16x16x32_bf16 v[92:95], v[172:175], v[180:183], v[92:95]
    s_waitcnt lgkmcnt(7)
    v_mfma_f32_16x16x32_bf16 v[96:99], v[160:163], v[184:187], v[96:99]
    ds_read_b64_tr_b16 v[132:133], v41 offset:0
    ds_read_b64_tr_b16 v[134:135], v41 offset:1024
    v_mfma_f32_16x16x32_bf16 v[100:103], v[164:167], v[184:187], v[100:103]
    buffer_load_dwordx4 v197, s[12:15], s45 offen offset:1024 nt lds
    v_mfma_f32_16x16x32_bf16 v[104:107], v[168:171], v[184:187], v[104:107]
    ds_read_b64_tr_b16 a[4:5], v41 offset:8192
    ds_read_b64_tr_b16 a[6:7], v41 offset:9216
    v_mfma_f32_16x16x32_bf16 v[108:111], v[172:175], v[184:187], v[108:111]
    s_waitcnt lgkmcnt(10)
    v_mfma_f32_16x16x32_bf16 v[112:115], v[160:163], v[188:191], v[112:115]
    ds_read_b128 v[148:151], v38 offset:2048
    v_mfma_f32_16x16x32_bf16 v[116:119], v[164:167], v[188:191], v[116:119]
    buffer_load_dwordx4 v198, s[12:15], s45 offen offset:2048 nt lds
    v_mfma_f32_16x16x32_bf16 v[120:123], v[168:171], v[188:191], v[120:123]
    ds_read_b128 a[20:23], v39 offset:2048
    v_mfma_f32_16x16x32_bf16 v[124:127], v[172:175], v[188:191], v[124:127]
    s_waitcnt lgkmcnt(8)
    v_mfma_f32_16x16x32_bf16 v[64:67], v[128:131], v[144:147], v[64:67]
    ds_read_b128 v[152:155], v38 offset:8192
    s_waitcnt lgkmcnt(5)
    v_mfma_f32_16x16x32_bf16 v[68:71], v[132:135], v[144:147], v[68:71]
    buffer_load_dwordx4 v199, s[12:15], s45 offen offset:3072 nt lds
    v_mfma_f32_16x16x32_bf16 v[64:67], a[0:3], a[16:19], v[64:67]
    ds_read_b128 a[24:27], v39 offset:8192
    s_waitcnt lgkmcnt(4)
    v_mfma_f32_16x16x32_bf16 v[68:71], a[4:7], a[16:19], v[68:71]
    s_waitcnt lgkmcnt(3)
    v_mfma_f32_16x16x32_bf16 v[80:83], v[128:131], v[148:151], v[80:83]
    ds_read_b64_tr_b16 v[136:137], v42 offset:0
    ds_read_b64_tr_b16 v[138:139], v42 offset:1024
    v_mfma_f32_16x16x32_bf16 v[84:87], v[132:135], v[148:151], v[84:87]
    s_waitcnt lgkmcnt(4)
    v_mfma_f32_16x16x32_bf16 v[80:83], a[0:3], a[20:23], v[80:83]
    ds_read_b64_tr_b16 a[8:9], v42 offset:8192
    ds_read_b64_tr_b16 a[10:11], v42 offset:9216
    v_mul_f32 v64, s52, v64
    v_mul_f32 v65, s52, v65
    v_mul_f32 v66, s52, v66
    v_mul_f32 v67, s52, v67
    v_mfma_f32_16x16x32_bf16 v[84:87], a[4:7], a[20:23], v[84:87]
    v_mul_f32 v68, s52, v68
    v_mul_f32 v69, s52, v69
    v_mul_f32 v70, s52, v70
    v_mul_f32 v71, s52, v71
    s_waitcnt lgkmcnt(5)
    v_mfma_f32_16x16x32_bf16 v[96:99], v[128:131], v[152:155], v[96:99]
    ds_read_b64_tr_b16 v[140:141], v43 offset:0
    ds_read_b64_tr_b16 v[142:143], v43 offset:1024
    v_cvt_pk_bf16_f32 v44, v64, v65
    v_cvt_pk_bf16_f32 v46, v68, v69
    v_cvt_pk_bf16_f32 v45, v66, v67
    v_mfma_f32_16x16x32_bf16 v[100:103], v[132:135], v[152:155], v[100:103]
    v_cvt_pk_bf16_f32 v47, v70, v71
    v_permlane16_swap_b32 v44, v46
    s_nop 0
    v_permlane16_swap_b32 v45, v47
    buffer_store_dwordx4 v[44:47], v30, s[36:39], s56 offen offset:0
    s_waitcnt lgkmcnt(6)
    v_mfma_f32_16x16x32_bf16 v[96:99], a[0:3], a[24:27], v[96:99]
    ds_read_b64_tr_b16 a[12:13], v43 offset:8192
    ds_read_b64_tr_b16 a[14:15], v43 offset:9216
    v_mul_f32 v80, s52, v80
    v_mul_f32 v81, s52, v81
    v_mul_f32 v82, s52, v82
    v_mul_f32 v83, s52, v83
    v_mfma_f32_16x16x32_bf16 v[100:103], a[4:7], a[24:27], v[100:103]
    v_mul_f32 v84, s52, v84
    v_mul_f32 v85, s52, v85
    v_mul_f32 v86, s52, v86
    v_mul_f32 v87, s52, v87
    s_waitcnt lgkmcnt(6)
    v_mfma_f32_16x16x32_bf16 v[72:75], v[136:139], v[144:147], v[72:75]
    ds_read_b128 v[156:159], v38 offset:10240
    v_cvt_pk_bf16_f32 v48, v80, v81
    v_cvt_pk_bf16_f32 v50, v84, v85
    v_cvt_pk_bf16_f32 v49, v82, v83
    s_waitcnt lgkmcnt(3)
    v_mfma_f32_16x16x32_bf16 v[76:79], v[140:143], v[144:147], v[76:79]
    v_cvt_pk_bf16_f32 v51, v86, v87
    v_permlane16_swap_b32 v48, v50
    s_nop 0
    v_permlane16_swap_b32 v49, v51
    buffer_store_dwordx4 v[48:51], v30, s[36:39], s56 offen offset:2048
    v_mfma_f32_16x16x32_bf16 v[72:75], a[8:11], a[16:19], v[72:75]
    ds_read_b128 a[28:31], v39 offset:10240
    v_mul_f32 v96, s52, v96
    v_mul_f32 v97, s52, v97
    v_mul_f32 v98, s52, v98
    v_mul_f32 v99, s52, v99
    s_waitcnt lgkmcnt(2)
    v_mfma_f32_16x16x32_bf16 v[76:79], a[12:15], a[16:19], v[76:79]
    v_mul_f32 v100, s52, v100
    v_mul_f32 v101, s52, v101
    v_mul_f32 v102, s52, v102
    v_mul_f32 v103, s52, v103
    v_mfma_f32_16x16x32_bf16 v[88:91], v[136:139], v[148:151], v[88:91]
    v_cvt_pk_bf16_f32 v52, v96, v97
    v_cvt_pk_bf16_f32 v54, v100, v101
    v_cvt_pk_bf16_f32 v53, v98, v99
    v_mfma_f32_16x16x32_bf16 v[92:95], v[140:143], v[148:151], v[92:95]
    v_cvt_pk_bf16_f32 v55, v102, v103
    v_permlane16_swap_b32 v52, v54
    s_nop 0
    v_permlane16_swap_b32 v53, v55
    buffer_store_dwordx4 v[52:55], v30, s[36:39], s43 offen offset:0
    v_mfma_f32_16x16x32_bf16 v[88:91], a[8:11], a[20:23], v[88:91]
    v_mul_f32 v72, s52, v72
    v_mul_f32 v73, s52, v73
    v_mul_f32 v74, s52, v74
    v_mul_f32 v75, s52, v75
    v_mfma_f32_16x16x32_bf16 v[92:95], a[12:15], a[20:23], v[92:95]
    v_mul_f32 v76, s52, v76
    v_mul_f32 v77, s52, v77
    v_mul_f32 v78, s52, v78
    v_mul_f32 v79, s52, v79
    v_mfma_f32_16x16x32_bf16 v[104:107], v[136:139], v[152:155], v[104:107]
    v_cvt_pk_bf16_f32 v56, v72, v73
    v_cvt_pk_bf16_f32 v58, v76, v77
    v_cvt_pk_bf16_f32 v57, v74, v75
    v_mfma_f32_16x16x32_bf16 v[108:111], v[140:143], v[152:155], v[108:111]
    v_cvt_pk_bf16_f32 v59, v78, v79
    v_permlane16_swap_b32 v56, v58
    s_nop 0
    v_permlane16_swap_b32 v57, v59
    buffer_store_dwordx4 v[56:59], v30, s[36:39], s56 offen offset:1024
    v_mfma_f32_16x16x32_bf16 v[104:107], a[8:11], a[24:27], v[104:107]
    v_mul_f32 v88, s52, v88
    v_mul_f32 v89, s52, v89
    v_mul_f32 v90, s52, v90
    v_mul_f32 v91, s52, v91
    v_mfma_f32_16x16x32_bf16 v[108:111], a[12:15], a[24:27], v[108:111]
    v_mul_f32 v92, s52, v92
    v_mul_f32 v93, s52, v93
    v_mul_f32 v94, s52, v94
    v_mul_f32 v95, s52, v95
    s_waitcnt lgkmcnt(1)
    v_mfma_f32_16x16x32_bf16 v[112:115], v[128:131], v[156:159], v[112:115]
    v_cvt_pk_bf16_f32 v60, v88, v89
    v_cvt_pk_bf16_f32 v62, v92, v93
    v_cvt_pk_bf16_f32 v61, v90, v91
    v_mfma_f32_16x16x32_bf16 v[116:119], v[132:135], v[156:159], v[116:119]
    v_cvt_pk_bf16_f32 v63, v94, v95
    v_permlane16_swap_b32 v60, v62
    s_nop 0
    v_permlane16_swap_b32 v61, v63
    buffer_store_dwordx4 v[60:63], v30, s[36:39], s56 offen offset:3072
    s_waitcnt lgkmcnt(0)
    v_mfma_f32_16x16x32_bf16 v[112:115], a[0:3], a[28:31], v[112:115]
    v_mul_f32 v104, s52, v104
    v_mul_f32 v105, s52, v105
    v_mul_f32 v106, s52, v106
    v_mul_f32 v107, s52, v107
    v_mfma_f32_16x16x32_bf16 v[116:119], a[4:7], a[28:31], v[116:119]
    v_mul_f32 v108, s52, v108
    v_mul_f32 v109, s52, v109
    v_mul_f32 v110, s52, v110
    v_mul_f32 v111, s52, v111
    v_mfma_f32_16x16x32_bf16 v[120:123], v[136:139], v[156:159], v[120:123]
    v_cvt_pk_bf16_f32 v44, v104, v105
    v_cvt_pk_bf16_f32 v46, v108, v109
    v_cvt_pk_bf16_f32 v45, v106, v107
    v_mfma_f32_16x16x32_bf16 v[124:127], v[140:143], v[156:159], v[124:127]
    v_cvt_pk_bf16_f32 v47, v110, v111
    v_permlane16_swap_b32 v44, v46
    s_nop 0
    v_permlane16_swap_b32 v45, v47
    buffer_store_dwordx4 v[44:47], v30, s[36:39], s43 offen offset:1024
    v_mfma_f32_16x16x32_bf16 v[120:123], a[8:11], a[28:31], v[120:123]
    v_mfma_f32_16x16x32_bf16 v[124:127], a[12:15], a[28:31], v[124:127]
    v_mul_f32 v112, s52, v112
    v_mul_f32 v113, s52, v113
    v_mul_f32 v114, s52, v114
    v_mul_f32 v115, s52, v115
    v_mul_f32 v116, s52, v116
    v_mul_f32 v117, s52, v117
    v_mul_f32 v118, s52, v118
    v_mul_f32 v119, s52, v119
    v_cvt_pk_bf16_f32 v48, v112, v113
    v_cvt_pk_bf16_f32 v50, v116, v117
    v_cvt_pk_bf16_f32 v49, v114, v115
    v_cvt_pk_bf16_f32 v51, v118, v119
    v_permlane16_swap_b32 v48, v50
    s_nop 0
    v_permlane16_swap_b32 v49, v51
    buffer_store_dwordx4 v[48:51], v30, s[36:39], s43 offen offset:2048
    v_mul_f32 v120, s52, v120
    v_mul_f32 v121, s52, v121
    v_mul_f32 v122, s52, v122
    v_mul_f32 v123, s52, v123
    v_mul_f32 v124, s52, v124
    v_mul_f32 v125, s52, v125
    v_mul_f32 v126, s52, v126
    v_mul_f32 v127, s52, v127
    v_cvt_pk_bf16_f32 v52, v120, v121
    v_cvt_pk_bf16_f32 v54, v124, v125
    v_cvt_pk_bf16_f32 v53, v122, v123
    v_cvt_pk_bf16_f32 v55, v126, v127
    v_permlane16_swap_b32 v52, v54
    s_nop 0
    v_permlane16_swap_b32 v53, v55
    buffer_store_dwordx4 v[52:55], v30, s[36:39], s43 offen offset:3072
    s_waitcnt vmcnt(16)
    v_cmp_gt_u32 vcc, s46, v237
    s_mov_b32 s51, 0
    s_cbranch_vccnz L3
L4:
    s_waitcnt vmcnt(0)
    s_barrier
    s_mov_b32 s53, 1024
    buffer_store_dword v233, v235, s[36:39], s53 offen
    s_branch L_rest
L_n1:
    s_lshl_b32 s53, 2, s7
    s_add_u32 s53, s53, s51
    v_cmp_gt_u32 vcc, 1, v17
    s_nop 1
    v_cndmask_b32 v57, v11, v16, vcc
    buffer_load_dword v49, v57, s[8:11], s53 offen
    s_mov_b64 s[12:13], s[86:87]
    s_mov_b32 s14, 33554432
    s_mov_b32 s15, 0x20000
    s_mov_b64 s[16:17], s[88:89]
    s_mov_b32 s18, 33554432
    s_mov_b32 s19, 0x20000
    s_mov_b64 s[24:25], s[92:93]
    s_mov_b32 s26, 3670016
    s_mov_b32 s27, 0x20000
    s_mov_b64 s[28:29], s[94:95]
    s_mov_b32 s30, 458752
    s_mov_b32 s31, 0x20000
    s_mov_b64 s[32:33], s[96:97]
    s_mov_b32 s34, 256
    s_mov_b32 s35, 0x20000
    s_mov_b64 s[36:37], s[98:99]
    s_mov_b32 s38, 268435456
    s_mov_b32 s39, 0x20000
    s_lshr_b32 s43, s2, 3
    s_lshl_b32 s44, s3, 5
    s_add_u32 s44, s44, s43
    s_lshl_b32 s56, s44, 14
    s_lshl3_add_u32 s40, s4, s3
    s_and_b32 s44, s4, 3
    s_xor_b32 s44, s44, s5
    s_lshl2_add_u32 s40, s40, s44
    s_lshl3_add_u32 s40, s40, s4
    s_lshl_b32 s40, s40, 14
    s_sub_u32 s44, s2, s3
    s_lshl2_add_u32 s44, s44, s6
    s_cmp_eq_u32 s44, 129
    s_cbranch_scc0 L6
    v_lshrrev_b32 v2, 1, v226
    v_and_b32 v5, 1, v226
    v_lshlrev_b32 v5, 4, v5
    v_lshl_add_u32 v10, v2, 7, v5
    v_mov_b32 v12, 0
    v_mov_b32 v13, 0
    v_mov_b32 v14, 0
    v_mov_b32 v15, 0
    s_lshl_b32 s53, s3, 13
    s_add_u32 s53, s53, 33554432
    buffer_store_dwordx4 v[12:15], v10, s[36:39], s53 offen sc1
    s_add_u32 s53, s53, 4096
    buffer_store_dwordx4 v[12:15], v10, s[36:39], s53 offen sc1
L6:
    s_sub_u32 s44, s2, s3
    s_lshl2_add_u32 s44, s44, s6
    s_cmp_eq_u32 s44, 129
    s_cbranch_scc0 L8
    v_lshlrev_b32 v10, 8, v226
    v_mov_b32 v12, 1
    s_lshl_b32 s53, s3, 2
    s_waitcnt vmcnt(0)
    buffer_store_dword v12, v10, s[32:35], s53 offen sc1
L8:
    s_lshl_b32 s53, 3, s7
    s_add_u32 s53, s53, s51
    v_cmp_gt_u32 vcc, 2, v17
    s_nop 1
    v_cndmask_b32 v58, v11, v16, vcc
    buffer_load_dword v50, v58, s[8:11], s53 offen
    s_lshr_b32 s45, s4, 1
    s_lshl2_add_u32 s45, s45, s5
    s_lshl2_add_u32 s45, s45, s6
    s_lshl_b32 s45, s45, 6
    s_getpc_b64 s[84:85]
L_pc:
    s_sub_u32 s84, s84, L_pc - standalone__gqa_block_cached__near_ridge_kernel
    s_subb_u32 s85, s85, 0
    s_add_u32 s84, s84, s45
    s_addc_u32 s85, s85, 0
    s_load_dword s86, s[84:85], 0
    s_load_dword s87, s[84:85], 4096
    s_load_dword s88, s[84:85], 8192
    s_load_dword s89, s[84:85], 12288
    s_load_dword s90, s[84:85], 16384
    s_load_dword s91, s[84:85], 20480
    s_load_dword s92, s[84:85], 24576
    v_lshrrev_b32 v3, 4, v226
    v_and_b32 v4, 15, v226
    s_lshl_b32 s41, s6, 12
    s_lshl_b32 s53, s6, 4
    v_add_u32 v9, s53, v3
    v_lshlrev_b32 v227, 4, v226
    v_add_u32 v234, s41, v227
    s_lshl_b32 s43, s3, 6
    s_add_u32 s43, s43, s4
    s_lshl_b32 s43, s43, 7
    s_add_u32 s43, s43, 33554432
    v_and_b32 v2, 3, v226
    v_xor_b32 v2, s5, v2
    v_lshl_add_u32 v236, v2, 3, s43
    s_andn2_b32 s43, s43, 128
    s_add_u32 s54, s36, s43
    s_addc_u32 s55, s37, 0
    v_mov_b32 v8, 268435456
    v_cmp_eq_u32 vcc, 0, v0
    v_and_b32 v2, 7, v226
    v_lshl_add_u32 v31, v2, 2, s41
    v_cndmask_b32 v235, v8, v236, vcc
    s_cmp_eq_u32 s6, 0
    s_cselect_b32 s46, 1, 0
    s_getreg_b32 s43, hwreg(HW_REG_XCC_ID, 0, 4)
    s_add_u32 s42, s43, 1
    v_mov_b32 v233, s42
    v_and_b32 v2, 31, v226
    v_lshrrev_b32 v8, 5, v226
    s_and_b32 s44, s6, 1
    v_lshl_add_u32 v22, s44, 3, v8
    v_xor_b32 v22, v22, v2
    v_lshlrev_b32 v22, 4, v22
    v_lshl_add_u32 v22, v8, 9, v22
    v_add_u32 v196, s41, v22
    v_xor_b32 v197, 32, v196
    v_xor_b32 v198, 64, v196
    v_xor_b32 v199, 96, v196
    s_lshl_b32 s53, 5, s7
    s_add_u32 s53, s53, s51
    v_cmp_gt_u32 vcc, 2, v17
    s_nop 1
    v_cndmask_b32 v59, v11, v16, vcc
    buffer_load_dword v51, v59, s[8:11], s53 offen
    s_waitcnt vmcnt(0)
    s_barrier
    v_lshlrev_b32 v25, 7, v0
    s_xor_b32 s53, s40, 4341760
    buffer_load_dword v27, v25, s[12:15], s53 offen
    v_and_b32 v24, 128, v0
    v_mad_u32_u24 v24, v24, 3, v0
    v_lshlrev_b32 v24, 7, v24
    s_sub_u32 s53, s56, 65536
    buffer_load_dword v33, v24, s[36:39], s53 offen
    buffer_load_dword v237, v31, s[32:35], 0 offen sc1
    s_lshr_b32 s53, s4, 1
    s_lshl2_add_u32 s53, s3, s53
    s_lshl2_add_u32 s53, s53, s5
    s_mul_i32 s53, s53, 28672
    v_min_u32 v26, 223, v0
    v_lshlrev_b32 v26, 7, v26
    buffer_load_dword v28, v26, s[24:27], s53 offen
    s_waitcnt vmcnt(1)
    v_cmp_gt_u32 vcc, s46, v237
    s_mov_b32 s51, 0
    s_cbranch_vccnz L11
L12:
    buffer_store_dword v233, v235, s[36:39], 0 offen offset:4 sc1
    s_add_u32 m0, s41, 0
    s_xor_b32 s45, s40, 0
    buffer_load_dwordx4 v196, s[12:15], s45 offen offset:0 nt lds
    buffer_load_dwordx4 v197, s[12:15], s45 offen offset:1024 nt lds
    buffer_load_dwordx4 v198, s[12:15], s45 offen offset:2048 nt lds
    buffer_load_dwordx4 v199, s[12:15], s45 offen offset:3072 nt lds
    s_add_u32 m0, s41, 16384
    s_xor_b32 s45, s40, 16384
    buffer_load_dwordx4 v196, s[12:15], s45 offen offset:0 nt lds
    buffer_load_dwordx4 v197, s[12:15], s45 offen offset:1024 nt lds
    buffer_load_dwordx4 v198, s[12:15], s45 offen offset:2048 nt lds
    buffer_load_dwordx4 v199, s[12:15], s45 offen offset:3072 nt lds
L_rest:
    v_and_b32 v2, 0xffffff7f, v236
    s_mov_b32 s53, 1024
    s_waitcnt lgkmcnt(0)
    s_mov_b32 s51, 0
    s_cmp_lg_u32 s6, 0
    s_cbranch_scc1 L13
L14:
    s_add_u32 s51, s51, 1
    s_cmp_gt_u32 s51, 262144
    s_cbranch_scc1 L13
    buffer_load_dword v237, v2, s[36:39], s53 offen sc1
    s_waitcnt vmcnt(0)
    v_cmp_ne_u32 vcc, v237, v233
    s_cmp_lt_u32 s51, 24
    s_nop 0
    s_cbranch_vccz L13
    s_cbranch_scc1 L14
    buffer_store_dword v233, v235, s[36:39], 0 offen offset:4 sc1
    s_load_dwordx8 s[84:91], s[54:55], 0 glc
    s_waitcnt lgkmcnt(0)
    s_min_u32 s43, s85, s87
    s_min_u32 s43, s43, s89
    s_min_u32 s43, s43, s91
    s_cmp_eq_u32 s43, 0
    s_cbranch_scc1 L14
    s_xor_b32 s44, s43, s42
    s_max_u32 s43, s85, s87
    s_max_u32 s43, s43, s89
    s_max_u32 s43, s43, s91
    s_xor_b32 s43, s43, s42
    s_or_b32 s43, s43, s44
    s_cbranch_scc0 L14
    s_bitcmp1_b32 s4, 0
    s_cbranch_scc1 L15
    buffer_wbl2 sc1
    v_mov_b32 v232, 2
    s_waitcnt vmcnt(0)
    buffer_store_dword v232, v235, s[36:39], 0 offen sc1
L15:
    s_add_u32 s51, s51, 1
    s_cmp_gt_u32 s51, 262144
    s_cbranch_scc1 L13
    s_load_dwordx8 s[84:91], s[54:55], 0 glc
    s_waitcnt lgkmcnt(0)
    s_min_u32 s43, s84, s86
    s_min_u32 s43, s43, s88
    s_min_u32 s43, s43, s90
    s_cmp_lt_u32 s43, 2
    s_cbranch_scc1 L15
    buffer_inv sc1
    s_waitcnt vmcnt(0)
L13:
    s_barrier
    s_andn2_b32 s43, s56, 49152
    buffer_load_dwordx4 a[0:3], v234, s[36:39], s43 offen offset:0 sc1
    buffer_load_dwordx4 a[4:7], v234, s[36:39], s43 offen offset:1024 sc1
    buffer_load_dwordx4 a[8:11], v234, s[36:39], s43 offen offset:2048 sc1
    buffer_load_dwordx4 a[12:15], v234, s[36:39], s43 offen offset:3072 sc1
    s_add_u32 s43, s43, 16384
    buffer_load_dwordx4 a[16:19], v234, s[36:39], s43 offen offset:0 sc1
    v_bfe_u32 v250, v226, 2, 1
    v_mul_u32_u24 v5, 892, v250
    v_sub_u32 v5, 1024, v5
    v_add_u32 v254, v2, v5
    v_xor_b32 v5, v4, v3
    v_lshlrev_b32 v5, 4, v5
    v_lshl_add_u32 v192, v4, 9, v5
    v_xor_b32 v193, 64, v192
    v_xor_b32 v194, 128, v192
    v_xor_b32 v195, 192, v192
    s_xor_b32 s57, s56, 16384
    s_xor_b32 s58, s56, 32768
    buffer_load_dwordx4 a[20:23], v234, s[36:39], s43 offen offset:1024 sc1
    s_xor_b32 s59, s56, 49152
    s_andn2_b32 s52, s40, 0xc000
    s_lshl_b32 s44, s5, 7
    s_add_u32 s52, s52, s44
    s_mul_i32 s47, s3, 458752
    buffer_load_dwordx4 a[24:27], v234, s[36:39], s43 offen offset:2048 sc1
    s_lshl1_add_u32 s47, s44, s47
    v_lshlrev_b32 v22, 1, v3
    v_xor_b32 v23, v4, v22
    v_mul_u32_u24 v5, 896, v9
    v_lshl_add_u32 v204, v23, 4, v5
    v_xor_b32 v23, 8, v23
    buffer_load_dwordx4 a[28:31], v234, s[36:39], s43 offen offset:3072 sc1
    v_lshl_add_u32 v23, v23, 4, v5
    v_add_u32 v205, 2560, v23
    v_add_u32 v206, 5120, v204
    v_add_u32 v207, 7680, v23
    v_lshrrev_b32 v23, 3, v226
    v_lshl_add_u32 v23, s6, 5, v23
    s_add_u32 s43, s43, 16384
    buffer_load_dwordx4 a[32:35], v234, s[36:39], s43 offen offset:0 sc1
    v_and_b32 v5, 7, v226
    v_xor_b32 v5, v5, v22
    v_lshlrev_b32 v5, 4, v5
    v_lshl_add_u32 v200, v23, 9, v5
    s_and_b32 s44, s40, 0xc000
    buffer_load_dwordx4 a[36:39], v234, s[36:39], s43 offen offset:1024 sc1
    v_xor_b32 v200, s44, v200
    v_add_u32 v201, 3072, v200
    v_add_u32 v202, 6144, v200
    v_add_u32 v203, 9216, v200
    s_lshl_b32 s44, s6, 8
    s_add_u32 s44, s44, 12582912
    buffer_load_dwordx4 a[40:43], v234, s[36:39], s43 offen offset:2048 sc1
    v_lshl_add_u32 v253, v4, 4, s44
    v_lshrrev_b32 v22, 2, v226
    v_and_b32 v23, 3, v226
    v_lshlrev_b32 v23, 3, v23
    v_bfe_u32 v5, v226, 3, 2
    v_lshl_add_u32 v5, v5, 5, v23
    buffer_load_dwordx4 a[44:47], v234, s[36:39], s43 offen offset:3072 sc1
    v_lshl_add_u32 v208, v22, 7, v5
    v_xor_b32 v209, 32, v208
    v_xor_b32 v210, 64, v208
    v_xor_b32 v211, 96, v208
    v_and_b32 v5, 7, v22
    s_add_u32 s43, s43, 16384
    buffer_load_dwordx4 a[48:51], v234, s[36:39], s43 offen offset:0 sc1
    s_lshl_b32 s44, s6, 1
    v_xor_b32 v5, s44, v5
    v_lshl_add_u32 v5, v5, 5, v23
    v_lshl_add_u32 v220, v22, 8, v5
    v_xor_b32 v221, 32, v220
    v_add_u32 v212, 65536, v208
    buffer_load_dwordx4 a[52:55], v234, s[36:39], s43 offen offset:1024 sc1
    v_add_u32 v213, 65536, v209
    v_add_u32 v214, 65536, v210
    v_add_u32 v215, 65536, v211
    v_add_u32 v222, 65536, v220
    v_add_u32 v223, 65536, v221
    v_add_u32 v216, 131072, v208
    buffer_load_dwordx4 a[56:59], v234, s[36:39], s43 offen offset:2048 sc1
    v_add_u32 v217, 131072, v209
    v_add_u32 v218, 131072, v210
    v_add_u32 v219, 131072, v211
    v_add_u32 v224, 131072, v220
    v_add_u32 v225, 131072, v221
    buffer_load_dwordx4 a[60:63], v234, s[36:39], s43 offen offset:3072 sc1
    s_waitcnt vmcnt(16)
    s_barrier
    s_add_u32 m0, s41, 32768
    s_xor_b32 s45, s40, 32768
    buffer_load_dwordx4 v196, s[12:15], s45 offen offset:0 nt lds
    buffer_load_dwordx4 v197, s[12:15], s45 offen offset:1024 nt lds
    buffer_load_dwordx4 v198, s[12:15], s45 offen offset:2048 nt lds
    buffer_load_dwordx4 v199, s[12:15], s45 offen offset:3072 nt lds
    s_add_u32 m0, s41, 49152
    s_xor_b32 s45, s40, 49152
    buffer_load_dwordx4 v196, s[12:15], s45 offen offset:0 nt lds
    buffer_load_dwordx4 v197, s[12:15], s45 offen offset:1024 nt lds
    buffer_load_dwordx4 v198, s[12:15], s45 offen offset:2048 nt lds
    buffer_load_dwordx4 v199, s[12:15], s45 offen offset:3072 nt lds
    s_mov_b32 s50, 0x41000000
    s_waitcnt vmcnt(8)
    s_barrier
    ds_read_b128 a[64:67], v192 offset:0
    ds_read_b128 a[68:71], v192 offset:8192
    ds_read_b128 a[72:75], v193 offset:0
    ds_read_b128 a[76:79], v193 offset:8192
    ds_read_b128 a[80:83], v194 offset:0
    ds_read_b128 a[84:87], v194 offset:8192
    ds_read_b128 a[88:91], v195 offset:0
    s_waitcnt lgkmcnt(6)
    v_mfma_f32_16x16x32_bf16 v[0:3], a[64:67], a[0:3], 0
    ds_read_b128 a[92:95], v195 offset:8192
    v_mfma_f32_16x16x32_bf16 v[8:11], a[64:67], a[8:11], 0
    s_waitcnt lgkmcnt(6)
    v_mfma_f32_16x16x32_bf16 v[4:7], a[68:71], a[0:3], 0
    ds_read_b128 a[96:99], v192 offset:256
    v_mfma_f32_16x16x32_bf16 v[12:15], a[68:71], a[8:11], 0
    s_waitcnt lgkmcnt(5)
    v_mfma_f32_16x16x32_bf16 v[0:3], a[72:75], a[4:7], v[0:3]
    ds_read_b128 a[100:103], v192 offset:8448
    v_mfma_f32_16x16x32_bf16 v[8:11], a[72:75], a[12:15], v[8:11]
    v_mfma_f32_16x16x32_bf16 v[4:7], a[76:79], a[4:7], v[4:7]
    ds_read_b128 a[104:107], v193 offset:256
    v_mfma_f32_16x16x32_bf16 v[12:15], a[76:79], a[12:15], v[12:15]
    s_waitcnt lgkmcnt(5)
    v_mfma_f32_16x16x32_bf16 v[0:3], a[80:83], a[16:19], v[0:3]
    ds_read_b128 a[108:111], v193 offset:8448
    v_mfma_f32_16x16x32_bf16 v[8:11], a[80:83], a[24:27], v[8:11]
    v_mfma_f32_16x16x32_bf16 v[4:7], a[84:87], a[16:19], v[4:7]
    ds_read_b128 a[112:115], v194 offset:256
    v_mfma_f32_16x16x32_bf16 v[12:15], a[84:87], a[24:27], v[12:15]
    s_waitcnt lgkmcnt(5)
    v_mfma_f32_16x16x32_bf16 v[0:3], a[88:91], a[20:23], v[0:3]
    ds_read_b128 a[116:119], v194 offset:8448
    v_mfma_f32_16x16x32_bf16 v[8:11], a[88:91], a[28:31], v[8:11]
    v_mfma_f32_16x16x32_bf16 v[4:7], a[92:95], a[20:23], v[4:7]
    ds_read_b128 a[120:123], v195 offset:256
    v_mfma_f32_16x16x32_bf16 v[12:15], a[92:95], a[28:31], v[12:15]
    s_waitcnt lgkmcnt(5)
    v_mfma_f32_16x16x32_bf16 v[0:3], a[96:99], a[32:35], v[0:3]
    ds_read_b128 a[124:127], v195 offset:8448
    v_mfma_f32_16x16x32_bf16 v[8:11], a[96:99], a[40:43], v[8:11]
    v_mfma_f32_16x16x32_bf16 v[4:7], a[100:103], a[32:35], v[4:7]
    ds_read_b128 a[64:67], v192 offset:16384
    v_mfma_f32_16x16x32_bf16 v[12:15], a[100:103], a[40:43], v[12:15]
    s_waitcnt lgkmcnt(5)
    v_mfma_f32_16x16x32_bf16 v[0:3], a[104:107], a[36:39], v[0:3]
    ds_read_b128 a[68:71], v192 offset:24576
    v_mfma_f32_16x16x32_bf16 v[8:11], a[104:107], a[44:47], v[8:11]
    s_add_u32 m0, s41, 131072
    s_xor_b32 s49, s5, 0
    s_mul_i32 s49, s49, 57344
    s_add_u32 s49, s49, s47
    buffer_load_dwordx4 v204, s[24:27], s49 offen offset:0  lds
    v_mfma_f32_16x16x32_bf16 v[4:7], a[108:111], a[36:39], v[4:7]
    ds_read_b128 a[72:75], v193 offset:16384
    v_mfma_f32_16x16x32_bf16 v[12:15], a[108:111], a[44:47], v[12:15]
    s_waitcnt lgkmcnt(5)
    v_mfma_f32_16x16x32_bf16 v[0:3], a[112:115], a[48:51], v[0:3]
    ds_read_b128 a[76:79], v193 offset:24576
    v_mfma_f32_16x16x32_bf16 v[8:11], a[112:115], a[56:59], v[8:11]
    buffer_load_dwordx4 v205, s[24:27], s49 offen offset:1024  lds
    v_mfma_f32_16x16x32_bf16 v[4:7], a[116:119], a[48:51], v[4:7]
    ds_read_b128 a[80:83], v194 offset:16384
    v_mfma_f32_16x16x32_bf16 v[12:15], a[116:119], a[56:59], v[12:15]
    s_waitcnt lgkmcnt(5)
    v_mfma_f32_16x16x32_bf16 v[0:3], a[120:123], a[52:55], v[0:3]
    ds_read_b128 a[84:87], v194 offset:24576
    v_mfma_f32_16x16x32_bf16 v[8:11], a[120:123], a[60:63], v[8:11]
    buffer_load_dwordx4 v206, s[24:27], s49 offen offset:2048  lds
    v_mfma_f32_16x16x32_bf16 v[4:7], a[124:127], a[52:55], v[4:7]
    ds_read_b128 a[88:91], v195 offset:16384
    v_mfma_f32_16x16x32_bf16 v[12:15], a[124:127], a[60:63], v[12:15]
    s_waitcnt lgkmcnt(5)
    v_mfma_f32_16x16x32_bf16 v[16:19], a[64:67], a[0:3], 0
    ds_read_b128 a[92:95], v195 offset:24576
    v_mfma_f32_16x16x32_bf16 v[24:27], a[64:67], a[8:11], 0
    buffer_load_dwordx4 v207, s[24:27], s49 offen offset:3072  lds
    v_mfma_f32_16x16x32_bf16 v[20:23], a[68:71], a[0:3], 0
    ds_read_b128 a[96:99], v192 offset:16640
    v_max3_f32 v238, v0, v1, v2
    v_max3_f32 v239, v8, v9, v10
    v_mfma_f32_16x16x32_bf16 v[28:31], a[68:71], a[8:11], 0
    v_max3_f32 v238, v238, v3, v4
    v_max3_f32 v239, v239, v11, v12
    v_max3_f32 v238, v238, v5, v6
    s_waitcnt lgkmcnt(5)
    v_mfma_f32_16x16x32_bf16 v[16:19], a[72:75], a[4:7], v[16:19]
    ds_read_b128 a[100:103], v192 offset:24832
    v_max3_f32 v239, v239, v13, v14
    v_max_f32 v238, v238, v7
    v_mfma_f32_16x16x32_bf16 v[24:27], a[72:75], a[12:15], v[24:27]
    v_max_f32 v239, v239, v15
    s_nop 1
    v_permlane32_swap_b32 v238, v239
    v_mfma_f32_16x16x32_bf16 v[20:23], a[76:79], a[4:7], v[20:23]
    ds_read_b128 a[104:107], v193 offset:16640
    v_max_f32 v238, v238, v239
    v_mov_b32 v239, v238
    v_mfma_f32_16x16x32_bf16 v[28:31], a[76:79], a[12:15], v[28:31]
    s_nop 0
    v_permlane16_swap_b32 v238, v239
    v_max_f32 v238, v238, v239
    s_waitcnt lgkmcnt(5)
    v_mfma_f32_16x16x32_bf16 v[16:19], a[80:83], a[16:19], v[16:19]
    ds_read_b128 a[108:111], v193 offset:24832
    v_mov_b32 v239, v238
    s_nop 1
    v_permlane32_swap_b32 v238, v239
    v_mfma_f32_16x16x32_bf16 v[24:27], a[80:83], a[24:27], v[24:27]
    v_mov_b32 v228, v238
    v_mov_b32 v229, v239
    v_mfma_f32_16x16x32_bf16 v[20:23], a[84:87], a[16:19], v[20:23]
    ds_read_b128 a[112:115], v194 offset:16640
    v_sub_f32 v242, 0, v238
    v_sub_f32 v243, 0, v238
    v_mfma_f32_16x16x32_bf16 v[28:31], a[84:87], a[24:27], v[28:31]
    v_sub_f32 v244, 0, v238
    v_sub_f32 v245, 0, v238
    s_waitcnt lgkmcnt(5)
    v_mfma_f32_16x16x32_bf16 v[16:19], a[88:91], a[20:23], v[16:19]
    ds_read_b128 a[116:119], v194 offset:24832
    v_sub_f32 v246, 0, v239
    v_sub_f32 v247, 0, v239
    v_mfma_f32_16x16x32_bf16 v[24:27], a[88:91], a[28:31], v[24:27]
    v_sub_f32 v248, 0, v239
    v_sub_f32 v249, 0, v239
    v_mfma_f32_16x16x32_bf16 v[20:23], a[92:95], a[20:23], v[20:23]
    ds_read_b128 a[120:123], v195 offset:16640
    v_sub_f32 v0, v0, v228
    v_sub_f32 v1, v1, v228
    v_mfma_f32_16x16x32_bf16 v[28:31], a[92:95], a[28:31], v[28:31]
    v_sub_f32 v2, v2, v228
    v_sub_f32 v3, v3, v228
    s_waitcnt lgkmcnt(5)
    v_mfma_f32_16x16x32_bf16 v[16:19], a[96:99], a[32:35], v[16:19]
    ds_read_b128 a[124:127], v195 offset:24832
    v_sub_f32 v4, v4, v228
    v_sub_f32 v5, v5, v228
    v_mfma_f32_16x16x32_bf16 v[24:27], a[96:99], a[40:43], v[24:27]
    v_sub_f32 v6, v6, v228
    v_sub_f32 v7, v7, v228
    v_mfma_f32_16x16x32_bf16 v[20:23], a[100:103], a[32:35], v[20:23]
    s_waitcnt vmcnt(8)
    s_barrier
    ds_read_b128 a[64:67], v192 offset:32768
    v_sub_f32 v8, v8, v229
    v_sub_f32 v9, v9, v229
    v_mfma_f32_16x16x32_bf16 v[28:31], a[100:103], a[40:43], v[28:31]
    v_sub_f32 v10, v10, v229
    v_sub_f32 v11, v11, v229
    s_waitcnt lgkmcnt(5)
    v_mfma_f32_16x16x32_bf16 v[16:19], a[104:107], a[36:39], v[16:19]
    ds_read_b128 a[68:71], v192 offset:40960
    v_sub_f32 v12, v12, v229
    v_sub_f32 v13, v13, v229
    v_mfma_f32_16x16x32_bf16 v[24:27], a[104:107], a[44:47], v[24:27]
    v_sub_f32 v14, v14, v229
    v_sub_f32 v15, v15, v229
    s_add_u32 m0, s41, 65536
    s_xor_b32 s45, s40, 65536
    buffer_load_dwordx4 v196, s[12:15], s45 offen offset:0 nt lds
    v_mfma_f32_16x16x32_bf16 v[20:23], a[108:111], a[36:39], v[20:23]
    ds_read_b128 a[72:75], v193 offset:32768
    v_exp_f32 v0, v0
    v_exp_f32 v1, v1
    v_mfma_f32_16x16x32_bf16 v[28:31], a[108:111], a[44:47], v[28:31]
    v_exp_f32 v2, v2
    v_exp_f32 v3, v3
    s_waitcnt lgkmcnt(5)
    v_mfma_f32_16x16x32_bf16 v[16:19], a[112:115], a[48:51], v[16:19]
    ds_read_b128 a[76:79], v193 offset:40960
    v_cvt_pk_bf16_f32 v128, v0, v1
    v_exp_f32 v4, v4
    v_mfma_f32_16x16x32_bf16 v[24:27], a[112:115], a[56:59], v[24:27]
    v_exp_f32 v5, v5
    v_cvt_pk_bf16_f32 v129, v2, v3
    buffer_load_dwordx4 v197, s[12:15], s45 offen offset:1024 nt lds
    v_mfma_f32_16x16x32_bf16 v[20:23], a[116:119], a[48:51], v[20:23]
    ds_read_b128 a[80:83], v194 offset:32768
    v_exp_f32 v6, v6
    v_exp_f32 v7, v7
    v_mfma_f32_16x16x32_bf16 v[28:31], a[116:119], a[56:59], v[28:31]
    v_cvt_pk_bf16_f32 v130, v4, v5
    v_exp_f32 v8, v8
    s_waitcnt lgkmcnt(5)
    v_mfma_f32_16x16x32_bf16 v[16:19], a[120:123], a[52:55], v[16:19]
    ds_read_b128 a[84:87], v194 offset:40960
    v_exp_f32 v9, v9
    v_cvt_pk_bf16_f32 v131, v6, v7
    v_mfma_f32_16x16x32_bf16 v[24:27], a[120:123], a[60:63], v[24:27]
    v_exp_f32 v10, v10
    v_exp_f32 v11, v11
    buffer_load_dwordx4 v198, s[12:15], s45 offen offset:2048 nt lds
    v_mfma_f32_16x16x32_bf16 v[20:23], a[124:127], a[52:55], v[20:23]
    ds_read_b128 a[88:91], v195 offset:32768
    v_cvt_pk_bf16_f32 v132, v8, v9
    v_exp_f32 v12, v12
    v_mfma_f32_16x16x32_bf16 v[28:31], a[124:127], a[60:63], v[28:31]
    v_exp_f32 v13, v13
    v_cvt_pk_bf16_f32 v133, v10, v11
    s_waitcnt lgkmcnt(5)
    v_mfma_f32_16x16x32_bf16 v[32:35], a[64:67], a[0:3], v[242:245]
    ds_read_b128 a[92:95], v195 offset:40960
    v_exp_f32 v14, v14
    v_exp_f32 v15, v15
    v_mfma_f32_16x16x32_bf16 v[40:43], a[64:67], a[8:11], v[246:249]
    v_cvt_pk_bf16_f32 v134, v12, v13
    v_cvt_pk_bf16_f32 v135, v14, v15
    buffer_load_dwordx4 v199, s[12:15], s45 offen offset:3072 nt lds
    v_mfma_f32_16x16x32_bf16 v[36:39], a[68:71], a[0:3], v[242:245]
    ds_read_b128 a[96:99], v192 offset:33024
    v_sub_f32 v16, v16, v228
    v_sub_f32 v17, v17, v228
    v_mfma_f32_16x16x32_bf16 v[44:47], a[68:71], a[8:11], v[246:249]
    v_sub_f32 v18, v18, v228
    v_sub_f32 v19, v19, v228
    s_waitcnt lgkmcnt(5)
    v_mfma_f32_16x16x32_bf16 v[32:35], a[72:75], a[4:7], v[32:35]
    ds_read_b128 a[100:103], v192 offset:41216
    v_sub_f32 v20, v20, v228
    v_mfma_f32_16x16x32_bf16 v[40:43], a[72:75], a[12:15], v[40:43]
    v_sub_f32 v21, v21, v228
    v_sub_f32 v22, v22, v228
    v_mfma_f32_16x16x32_bf16 v[36:39], a[76:79], a[4:7], v[36:39]
    ds_read_b128 a[104:107], v193 offset:33024
    v_sub_f32 v23, v23, v228
    v_mfma_f32_16x16x32_bf16 v[44:47], a[76:79], a[12:15], v[44:47]
    v_sub_f32 v24, v24, v229
    v_sub_f32 v25, v25, v229
    s_waitcnt lgkmcnt(5)
    v_mfma_f32_16x16x32_bf16 v[32:35], a[80:83], a[16:19], v[32:35]
    ds_read_b128 a[108:111], v193 offset:41216
    v_sub_f32 v26, v26, v229
    v_mfma_f32_16x16x32_bf16 v[40:43], a[80:83], a[24:27], v[40:43]
    v_sub_f32 v27, v27, v229
    v_sub_f32 v28, v28, v229
    v_mfma_f32_16x16x32_bf16 v[36:39], a[84:87], a[16:19], v[36:39]
    ds_read_b128 a[112:115], v194 offset:33024
    v_sub_f32 v29, v29, v229
    v_mfma_f32_16x16x32_bf16 v[44:47], a[84:87], a[24:27], v[44:47]
    v_sub_f32 v30, v30, v229
    v_sub_f32 v31, v31, v229
    s_waitcnt lgkmcnt(5)
    v_mfma_f32_16x16x32_bf16 v[32:35], a[88:91], a[20:23], v[32:35]
    ds_read_b128 a[116:119], v194 offset:41216
    v_max3_f32 v238, v16, v17, v18
    v_mfma_f32_16x16x32_bf16 v[40:43], a[88:91], a[28:31], v[40:43]
    v_max3_f32 v239, v24, v25, v26
    v_max3_f32 v238, v238, v19, v20
    v_mfma_f32_16x16x32_bf16 v[36:39], a[92:95], a[20:23], v[36:39]
    ds_read_b128 a[120:123], v195 offset:33024
    v_max3_f32 v239, v239, v27, v28
    v_mfma_f32_16x16x32_bf16 v[44:47], a[92:95], a[28:31], v[44:47]
    v_max3_f32 v238, v238, v21, v22
    v_max3_f32 v239, v239, v29, v30
    s_waitcnt lgkmcnt(5)
    v_mfma_f32_16x16x32_bf16 v[32:35], a[96:99], a[32:35], v[32:35]
    ds_read_b128 a[124:127], v195 offset:41216
    v_max_f32 v238, v238, v23
    v_mfma_f32_16x16x32_bf16 v[40:43], a[96:99], a[40:43], v[40:43]
    v_max_f32 v239, v239, v31
    v_max_f32 v240, v238, v239
    v_mfma_f32_16x16x32_bf16 v[36:39], a[100:103], a[32:35], v[36:39]
    s_waitcnt vmcnt(8)
    s_barrier
    buffer_load_dword v237, v254, s[36:39], 0 offen sc1
    ds_read_b128 a[64:67], v192 offset:49152
    v_cmp_lt_f32 vcc, s50, v240
    s_nop 0
    s_cbranch_vccnz L16
L17:
    v_exp_f32 v16, v16
    v_mfma_f32_16x16x32_bf16 v[44:47], a[100:103], a[40:43], v[44:47]
    v_exp_f32 v17, v17
    v_exp_f32 v18, v18
    s_waitcnt lgkmcnt(5)
    v_mfma_f32_16x16x32_bf16 v[32:35], a[104:107], a[36:39], v[32:35]
    ds_read_b128 a[68:71], v192 offset:57344
    v_exp_f32 v19, v19
    v_cvt_pk_bf16_f32 v136, v16, v17
    v_mfma_f32_16x16x32_bf16 v[40:43], a[104:107], a[44:47], v[40:43]
    v_exp_f32 v20, v20
    s_add_u32 m0, s41, 81920
    s_xor_b32 s45, s40, 81920
    buffer_load_dwordx4 v196, s[12:15], s45 offen offset:0 nt lds
    v_mfma_f32_16x16x32_bf16 v[36:39], a[108:111], a[36:39], v[36:39]
    ds_read_b128 a[72:75], v193 offset:49152
    v_exp_f32 v21, v21
    v_cvt_pk_bf16_f32 v137, v18, v19
    v_mfma_f32_16x16x32_bf16 v[44:47], a[108:111], a[44:47], v[44:47]
    v_exp_f32 v22, v22
    buffer_load_dwordx4 v197, s[12:15], s45 offen offset:1024 nt lds
    s_waitcnt lgkmcnt(5)
    v_mfma_f32_16x16x32_bf16 v[32:35], a[112:115], a[48:51], v[32:35]
    ds_read_b128 a[76:79], v193 offset:57344
    v_exp_f32 v23, v23
    v_mfma_f32_16x16x32_bf16 v[40:43], a[112:115], a[56:59], v[40:43]
    v_cvt_pk_bf16_f32 v138, v20, v21
    v_exp_f32 v24, v24
    v_mfma_f32_16x16x32_bf16 v[36:39], a[116:119], a[48:51], v[36:39]
    ds_read_b128 a[80:83], v194 offset:49152
    v_exp_f32 v25, v25
    v_cvt_pk_bf16_f32 v139, v22, v23
    v_mfma_f32_16x16x32_bf16 v[44:47], a[116:119], a[56:59], v[44:47]
    v_exp_f32 v26, v26
    buffer_load_dwordx4 v198, s[12:15], s45 offen offset:2048 nt lds
    s_waitcnt lgkmcnt(5)
    v_mfma_f32_16x16x32_bf16 v[32:35], a[120:123], a[52:55], v[32:35]
    ds_read_b128 a[84:87], v194 offset:57344
    v_exp_f32 v27, v27
    v_mfma_f32_16x16x32_bf16 v[40:43], a[120:123], a[60:63], v[40:43]
    v_cvt_pk_bf16_f32 v140, v24, v25
    v_exp_f32 v28, v28
    v_mfma_f32_16x16x32_bf16 v[36:39], a[124:127], a[52:55], v[36:39]
    ds_read_b128 a[88:91], v195 offset:49152
    v_exp_f32 v29, v29
    v_cvt_pk_bf16_f32 v141, v26, v27
    v_mfma_f32_16x16x32_bf16 v[44:47], a[124:127], a[60:63], v[44:47]
    v_exp_f32 v30, v30
    buffer_load_dwordx4 v199, s[12:15], s45 offen offset:3072 nt lds
    s_waitcnt lgkmcnt(5)
    v_mfma_f32_16x16x32_bf16 v[48:51], a[64:67], a[0:3], v[242:245]
    ds_read_b128 a[92:95], v195 offset:57344
    v_exp_f32 v31, v31
    v_mfma_f32_16x16x32_bf16 v[56:59], a[64:67], a[8:11], v[246:249]
    v_cvt_pk_bf16_f32 v142, v28, v29
    v_cvt_pk_bf16_f32 v143, v30, v31
    v_mfma_f32_16x16x32_bf16 v[52:55], a[68:71], a[0:3], v[242:245]
    ds_read_b128 a[96:99], v192 offset:49408
    v_max3_f32 v238, v32, v33, v34
    v_max3_f32 v239, v40, v41, v42
    v_mfma_f32_16x16x32_bf16 v[60:63], a[68:71], a[8:11], v[246:249]
    v_max3_f32 v238, v238, v35, v36
    s_add_u32 m0, s41, 147456
    s_xor_b32 s49, s5, 4
    s_mul_i32 s49, s49, 57344
    s_add_u32 s49, s49, s47
    buffer_load_dwordx4 v204, s[24:27], s49 offen offset:0  lds
    s_waitcnt lgkmcnt(5)
    v_mfma_f32_16x16x32_bf16 v[48:51], a[72:75], a[4:7], v[48:51]
    ds_read_b128 a[100:103], v192 offset:57600
    v_max3_f32 v239, v239, v43, v44
    v_mfma_f32_16x16x32_bf16 v[56:59], a[72:75], a[12:15], v[56:59]
    v_max3_f32 v238, v238, v37, v38
    v_mfma_f32_16x16x32_bf16 v[52:55], a[76:79], a[4:7], v[52:55]
    ds_read_b128 a[104:107], v193 offset:49408
    v_max3_f32 v239, v239, v45, v46
    v_mfma_f32_16x16x32_bf16 v[60:63], a[76:79], a[12:15], v[60:63]
    v_max_f32 v238, v238, v39
    buffer_load_dwordx4 v205, s[24:27], s49 offen offset:1024  lds
    s_waitcnt lgkmcnt(5)
    v_mfma_f32_16x16x32_bf16 v[48:51], a[80:83], a[16:19], v[48:51]
    ds_read_b128 a[108:111], v193 offset:57600
    v_max_f32 v239, v239, v47
    v_mfma_f32_16x16x32_bf16 v[56:59], a[80:83], a[24:27], v[56:59]
    v_max_f32 v240, v238, v239
    v_mfma_f32_16x16x32_bf16 v[52:55], a[84:87], a[16:19], v[52:55]
    ds_read_b128 a[112:115], v194 offset:49408
    v_cmp_lt_f32 vcc, s50, v240
    s_nop 0
    s_cbranch_vccnz L18
L19:
    v_mfma_f32_16x16x32_bf16 v[60:63], a[84:87], a[24:27], v[60:63]
    v_exp_f32 v32, v32
    buffer_load_dwordx4 v206, s[24:27], s49 offen offset:2048  lds
    s_waitcnt lgkmcnt(5)
    v_mfma_f32_16x16x32_bf16 v[48:51], a[88:91], a[20:23], v[48:51]
    ds_read_b128 a[116:119], v194 offset:57600
    v_exp_f32 v33, v33
    v_mfma_f32_16x16x32_bf16 v[56:59], a[88:91], a[28:31], v[56:59]
    v_exp_f32 v34, v34
    v_mfma_f32_16x16x32_bf16 v[52:55], a[92:95], a[20:23], v[52:55]
    ds_read_b128 a[120:123], v195 offset:49408
    v_exp_f32 v35, v35
    v_mfma_f32_16x16x32_bf16 v[60:63], a[92:95], a[28:31], v[60:63]
    v_cvt_pk_bf16_f32 v144, v32, v33
    buffer_load_dwordx4 v207, s[24:27], s49 offen offset:3072  lds
    s_waitcnt lgkmcnt(5)
    v_mfma_f32_16x16x32_bf16 v[48:51], a[96:99], a[32:35], v[48:51]
    ds_read_b128 a[124:127], v195 offset:57600
    v_exp_f32 v36, v36
    v_mfma_f32_16x16x32_bf16 v[56:59], a[96:99], a[40:43], v[56:59]
    v_exp_f32 v37, v37
    v_mfma_f32_16x16x32_bf16 v[52:55], a[100:103], a[32:35], v[52:55]
    s_waitcnt vmcnt(9)
    s_barrier
    v_add_u32 v192, 65536, v192
    v_add_u32 v193, 65536, v193
    v_add_u32 v194, 65536, v194
    v_add_u32 v195, 65536, v195
    ds_read_b64_tr_b16 a[128:129], v224 offset:0
    ds_read_b64_tr_b16 a[130:131], v224 offset:4096
    ds_read_b64_tr_b16 a[132:133], v225 offset:0
    ds_read_b64_tr_b16 a[134:135], v225 offset:4096
    ds_read_b64_tr_b16 a[136:137], v224 offset:8192
    ds_read_b64_tr_b16 a[138:139], v224 offset:12288
    ds_read_b64_tr_b16 a[140:141], v225 offset:8192
    ds_read_b64_tr_b16 a[142:143], v225 offset:12288
    ds_read_b128 a[64:67], v192 offset:0
    v_cvt_pk_bf16_f32 v145, v34, v35
    v_mfma_f32_16x16x32_bf16 v[60:63], a[100:103], a[40:43], v[60:63]
    v_exp_f32 v38, v38
    v_exp_f32 v39, v39
    s_waitcnt lgkmcnt(13)
    v_mfma_f32_16x16x32_bf16 v[48:51], a[104:107], a[36:39], v[48:51]
    ds_read_b128 a[68:71], v192 offset:8192
    v_cvt_pk_bf16_f32 v146, v36, v37
    v_mfma_f32_16x16x32_bf16 v[56:59], a[104:107], a[44:47], v[56:59]
    v_exp_f32 v40, v40
    s_add_u32 m0, s41, 98304
    s_xor_b32 s45, s40, 98304
    buffer_load_dwordx4 v196, s[12:15], s45 offen offset:0 nt lds
    v_mfma_f32_16x16x32_bf16 v[52:55], a[108:111], a[36:39], v[52:55]
    ds_read_b128 a[72:75], v193 offset:0
    v_exp_f32 v41, v41
    v_mfma_f32_16x16x32_bf16 v[60:63], a[108:111], a[44:47], v[60:63]
    v_cvt_pk_bf16_f32 v147, v38, v39
    s_waitcnt lgkmcnt(13)
    v_mfma_f32_16x16x32_bf16 v[48:51], a[112:115], a[48:51], v[48:51]
    ds_read_b128 a[76:79], v193 offset:8192
    v_exp_f32 v42, v42
    v_mfma_f32_16x16x32_bf16 v[56:59], a[112:115], a[56:59], v[56:59]
    v_exp_f32 v43, v43
    buffer_load_dwordx4 v197, s[12:15], s45 offen offset:1024 nt lds
    v_mfma_f32_16x16x32_bf16 v[52:55], a[116:119], a[48:51], v[52:55]
    ds_read_b128 a[80:83], v194 offset:0
    v_cvt_pk_bf16_f32 v148, v40, v41
    v_mfma_f32_16x16x32_bf16 v[60:63], a[116:119], a[56:59], v[60:63]
    v_exp_f32 v44, v44
    s_waitcnt lgkmcnt(13)
    v_mfma_f32_16x16x32_bf16 v[48:51], a[120:123], a[52:55], v[48:51]
    ds_read_b128 a[84:87], v194 offset:8192
    v_exp_f32 v45, v45
    v_mfma_f32_16x16x32_bf16 v[56:59], a[120:123], a[60:63], v[56:59]
    v_cvt_pk_bf16_f32 v149, v42, v43
    buffer_load_dwordx4 v198, s[12:15], s45 offen offset:2048 nt lds
    v_mfma_f32_16x16x32_bf16 v[52:55], a[124:127], a[52:55], v[52:55]
    ds_read_b128 a[88:91], v195 offset:0
    v_exp_f32 v46, v46
    v_mfma_f32_16x16x32_bf16 v[60:63], a[124:127], a[60:63], v[60:63]
    v_exp_f32 v47, v47
    s_waitcnt lgkmcnt(5)
    v_mfma_f32_16x16x32_bf16 v[64:67], a[64:67], a[0:3], v[242:245]
    ds_read_b128 a[92:95], v195 offset:8192
    v_cvt_pk_bf16_f32 v150, v44, v45
    v_mfma_f32_16x16x32_bf16 v[72:75], a[64:67], a[8:11], v[246:249]
    v_cvt_pk_bf16_f32 v151, v46, v47
    buffer_load_dwordx4 v199, s[12:15], s45 offen offset:3072 nt lds
    v_mfma_f32_16x16x32_bf16 v[68:71], a[68:71], a[0:3], v[242:245]
    ds_read_b128 a[96:99], v192 offset:256
    v_max3_f32 v238, v48, v49, v50
    v_mfma_f32_16x16x32_bf16 v[76:79], a[68:71], a[8:11], v[246:249]
    v_max3_f32 v239, v56, v57, v58
    v_max3_f32 v238, v238, v51, v52
    s_waitcnt lgkmcnt(5)
    v_mfma_f32_16x16x32_bf16 v[64:67], a[72:75], a[4:7], v[64:67]
    ds_read_b128 a[100:103], v192 offset:8448
    v_max3_f32 v239, v239, v59, v60
    v_mfma_f32_16x16x32_bf16 v[72:75], a[72:75], a[12:15], v[72:75]
    v_max3_f32 v238, v238, v53, v54
    v_mfma_f32_16x16x32_bf16 v[68:71], a[76:79], a[4:7], v[68:71]
    ds_read_b128 a[104:107], v193 offset:256
    v_max3_f32 v239, v239, v61, v62
    v_mfma_f32_16x16x32_bf16 v[76:79], a[76:79], a[12:15], v[76:79]
    v_max_f32 v238, v238, v55
    s_waitcnt lgkmcnt(5)
    v_mfma_f32_16x16x32_bf16 v[64:67], a[80:83], a[16:19], v[64:67]
    ds_read_b128 a[108:111], v193 offset:8448
    v_max_f32 v239, v239, v63
    v_mfma_f32_16x16x32_bf16 v[72:75], a[80:83], a[24:27], v[72:75]
    v_max_f32 v240, v238, v239
    v_mfma_f32_16x16x32_bf16 v[68:71], a[84:87], a[16:19], v[68:71]
    ds_read_b128 a[112:115], v194 offset:256
    v_cmp_lt_f32 vcc, s50, v240
    s_nop 0
    s_cbranch_vccnz L20
L21:
    v_mfma_f32_16x16x32_bf16 v[76:79], a[84:87], a[24:27], v[76:79]
    v_exp_f32 v48, v48
    s_waitcnt lgkmcnt(5)
    v_mfma_f32_16x16x32_bf16 v[64:67], a[88:91], a[20:23], v[64:67]
    ds_read_b128 a[116:119], v194 offset:8448
    v_exp_f32 v49, v49
    v_mfma_f32_16x16x32_bf16 v[72:75], a[88:91], a[28:31], v[72:75]
    v_exp_f32 v50, v50
    v_mfma_f32_16x16x32_bf16 v[68:71], a[92:95], a[20:23], v[68:71]
    ds_read_b128 a[120:123], v195 offset:256
    v_exp_f32 v51, v51
    v_mfma_f32_16x16x32_bf16 v[76:79], a[92:95], a[28:31], v[76:79]
    v_cvt_pk_bf16_f32 v152, v48, v49
    s_waitcnt lgkmcnt(5)
    v_mfma_f32_16x16x32_bf16 v[64:67], a[96:99], a[32:35], v[64:67]
    ds_read_b128 a[124:127], v195 offset:8448
    v_exp_f32 v52, v52
    v_mfma_f32_16x16x32_bf16 v[72:75], a[96:99], a[40:43], v[72:75]
    v_exp_f32 v53, v53
    v_mfma_f32_16x16x32_bf16 v[68:71], a[100:103], a[32:35], v[68:71]
    s_waitcnt vmcnt(8)
    s_barrier
    ds_read_b128 a[64:67], v192 offset:16384
    v_cvt_pk_bf16_f32 v153, v50, v51
    v_mfma_f32_16x16x32_bf16 v[76:79], a[100:103], a[40:43], v[76:79]
    v_exp_f32 v54, v54
    v_exp_f32 v55, v55
    s_waitcnt lgkmcnt(5)
    v_mfma_f32_16x16x32_bf16 v[64:67], a[104:107], a[36:39], v[64:67]
    ds_read_b128 a[68:71], v192 offset:24576
    v_cvt_pk_bf16_f32 v154, v52, v53
    v_mfma_f32_16x16x32_bf16 v[72:75], a[104:107], a[44:47], v[72:75]
    v_exp_f32 v56, v56
    s_add_u32 m0, s41, 114688
    s_xor_b32 s45, s40, 114688
    buffer_load_dwordx4 v196, s[12:15], s45 offen offset:0 nt lds
    v_mfma_f32_16x16x32_bf16 v[68:71], a[108:111], a[36:39], v[68:71]
    ds_read_b128 a[72:75], v193 offset:16384
    v_exp_f32 v57, v57
    v_mfma_f32_16x16x32_bf16 v[76:79], a[108:111], a[44:47], v[76:79]
    v_cvt_pk_bf16_f32 v155, v54, v55
    buffer_load_dwordx4 v197, s[12:15], s45 offen offset:1024 nt lds
    s_waitcnt lgkmcnt(5)
    v_mfma_f32_16x16x32_bf16 v[64:67], a[112:115], a[48:51], v[64:67]
    ds_read_b128 a[76:79], v193 offset:24576
    v_exp_f32 v58, v58
    v_mfma_f32_16x16x32_bf16 v[72:75], a[112:115], a[56:59], v[72:75]
    v_exp_f32 v59, v59
    v_mfma_f32_16x16x32_bf16 v[68:71], a[116:119], a[48:51], v[68:71]
    ds_read_b128 a[80:83], v194 offset:16384
    v_cvt_pk_bf16_f32 v156, v56, v57
    v_mfma_f32_16x16x32_bf16 v[76:79], a[116:119], a[56:59], v[76:79]
    v_exp_f32 v60, v60
    buffer_load_dwordx4 v198, s[12:15], s45 offen offset:2048 nt lds
    s_waitcnt lgkmcnt(5)
    v_mfma_f32_16x16x32_bf16 v[64:67], a[120:123], a[52:55], v[64:67]
    ds_read_b128 a[84:87], v194 offset:24576
    v_exp_f32 v61, v61
    v_mfma_f32_16x16x32_bf16 v[72:75], a[120:123], a[60:63], v[72:75]
    v_cvt_pk_bf16_f32 v157, v58, v59
    v_mfma_f32_16x16x32_bf16 v[68:71], a[124:127], a[52:55], v[68:71]
    ds_read_b128 a[88:91], v195 offset:16384
    v_exp_f32 v62, v62
    v_mfma_f32_16x16x32_bf16 v[76:79], a[124:127], a[60:63], v[76:79]
    v_exp_f32 v63, v63
    buffer_load_dwordx4 v199, s[12:15], s45 offen offset:3072 nt lds
    s_waitcnt lgkmcnt(5)
    v_mfma_f32_16x16x32_bf16 v[80:83], a[64:67], a[0:3], v[242:245]
    ds_read_b128 a[92:95], v195 offset:24576
    v_cvt_pk_bf16_f32 v158, v60, v61
    v_mfma_f32_16x16x32_bf16 v[88:91], a[64:67], a[8:11], v[246:249]
    v_cvt_pk_bf16_f32 v159, v62, v63
    v_mfma_f32_16x16x32_bf16 v[84:87], a[68:71], a[0:3], v[242:245]
    ds_read_b128 a[96:99], v192 offset:16640
    v_max3_f32 v238, v64, v65, v66
    v_max3_f32 v239, v72, v73, v74
    v_mfma_f32_16x16x32_bf16 v[92:95], a[68:71], a[8:11], v[246:249]
    v_max3_f32 v238, v238, v67, v68
    s_add_u32 m0, s41, 131072
    s_xor_b32 s49, s5, 1
    s_mul_i32 s49, s49, 57344
    s_add_u32 s49, s49, s47
    buffer_load_dwordx4 v204, s[24:27], s49 offen offset:0  lds
    s_waitcnt lgkmcnt(5)
    v_mfma_f32_16x16x32_bf16 v[80:83], a[72:75], a[4:7], v[80:83]
    ds_read_b128 a[100:103], v192 offset:24832
    v_max3_f32 v239, v239, v75, v76
    v_mfma_f32_16x16x32_bf16 v[88:91], a[72:75], a[12:15], v[88:91]
    v_max3_f32 v238, v238, v69, v70
    v_mfma_f32_16x16x32_bf16 v[84:87], a[76:79], a[4:7], v[84:87]
    ds_read_b128 a[104:107], v193 offset:16640
    v_max3_f32 v239, v239, v77, v78
    v_mfma_f32_16x16x32_bf16 v[92:95], a[76:79], a[12:15], v[92:95]
    v_max_f32 v238, v238, v71
    buffer_load_dwordx4 v205, s[24:27], s49 offen offset:1024  lds
    s_waitcnt lgkmcnt(5)
    v_mfma_f32_16x16x32_bf16 v[80:83], a[80:83], a[16:19], v[80:83]
    ds_read_b128 a[108:111], v193 offset:24832
    v_max_f32 v239, v239, v79
    v_mfma_f32_16x16x32_bf16 v[88:91], a[80:83], a[24:27], v[88:91]
    v_max_f32 v240, v238, v239
    v_mfma_f32_16x16x32_bf16 v[84:87], a[84:87], a[16:19], v[84:87]
    ds_read_b128 a[112:115], v194 offset:16640
    v_cmp_lt_f32 vcc, s50, v240
    s_nop 0
    s_cbranch_vccnz L22
L23:
    v_mfma_f32_16x16x32_bf16 v[92:95], a[84:87], a[24:27], v[92:95]
    v_exp_f32 v64, v64
    buffer_load_dwordx4 v206, s[24:27], s49 offen offset:2048  lds
    s_waitcnt lgkmcnt(5)
    v_mfma_f32_16x16x32_bf16 v[80:83], a[88:91], a[20:23], v[80:83]
    ds_read_b128 a[116:119], v194 offset:24832
    v_exp_f32 v65, v65
    v_mfma_f32_16x16x32_bf16 v[88:91], a[88:91], a[28:31], v[88:91]
    v_exp_f32 v66, v66
    v_mfma_f32_16x16x32_bf16 v[84:87], a[92:95], a[20:23], v[84:87]
    ds_read_b128 a[120:123], v195 offset:16640
    v_exp_f32 v67, v67
    v_mfma_f32_16x16x32_bf16 v[92:95], a[92:95], a[28:31], v[92:95]
    v_cvt_pk_bf16_f32 v160, v64, v65
    buffer_load_dwordx4 v207, s[24:27], s49 offen offset:3072  lds
    s_waitcnt lgkmcnt(5)
    v_mfma_f32_16x16x32_bf16 v[80:83], a[96:99], a[32:35], v[80:83]
    ds_read_b128 a[124:127], v195 offset:24832
    v_exp_f32 v68, v68
    v_mfma_f32_16x16x32_bf16 v[88:91], a[96:99], a[40:43], v[88:91]
    v_exp_f32 v69, v69
    v_mfma_f32_16x16x32_bf16 v[84:87], a[100:103], a[32:35], v[84:87]
    s_waitcnt vmcnt(8)
    s_barrier
    v_cmp_gt_u32 vcc, v250, v237
    s_mov_b32 s51, 0
    s_cbranch_vccnz L26
L27:
    v_cmp_ne_u32 vcc, v237, v233
    s_nop 0
    s_cmp_eq_u64 vcc, 0
    s_cselect_b32 s7, 1, 0
    s_cbranch_scc0 L28
L29:
    v_mov_b32 v232, 3
    s_or_b32 s53, s7, s6
    s_cbranch_scc0 L30
    buffer_store_dword v232, v235, s[36:39], 0 offen
L31:
    ds_read_b64_tr_b16 a[144:145], v224 offset:16384
    ds_read_b64_tr_b16 a[146:147], v224 offset:20480
    ds_read_b64_tr_b16 a[148:149], v225 offset:16384
    ds_read_b64_tr_b16 a[150:151], v225 offset:20480
    ds_read_b64_tr_b16 a[152:153], v224 offset:24576
    ds_read_b64_tr_b16 a[154:155], v224 offset:28672
    ds_read_b64_tr_b16 a[156:157], v225 offset:24576
    ds_read_b64_tr_b16 a[158:159], v225 offset:28672
    ds_read_b128 a[64:67], v192 offset:32768
    v_cvt_pk_bf16_f32 v161, v66, v67
    v_mfma_f32_16x16x32_bf16 v[92:95], a[100:103], a[40:43], v[92:95]
    v_exp_f32 v70, v70
    v_exp_f32 v71, v71
    s_waitcnt lgkmcnt(13)
    v_mfma_f32_16x16x32_bf16 v[80:83], a[104:107], a[36:39], v[80:83]
    ds_read_b128 a[68:71], v192 offset:40960
    v_cvt_pk_bf16_f32 v162, v68, v69
    v_mfma_f32_16x16x32_bf16 v[88:91], a[104:107], a[44:47], v[88:91]
    v_exp_f32 v72, v72
    s_add_u32 m0, s41, 65536
    s_xor_b32 s45, s52, 128
    buffer_load_dwordx4 v200, s[16:19], s45 offen offset:0 nt lds
    v_mfma_f32_16x16x32_bf16 v[84:87], a[108:111], a[36:39], v[84:87]
    ds_read_b128 a[72:75], v193 offset:32768
    v_exp_f32 v73, v73
    v_mfma_f32_16x16x32_bf16 v[92:95], a[108:111], a[44:47], v[92:95]
    v_cvt_pk_bf16_f32 v163, v70, v71
    s_waitcnt lgkmcnt(13)
    v_mfma_f32_16x16x32_bf16 v[80:83], a[112:115], a[48:51], v[80:83]
    ds_read_b128 a[76:79], v193 offset:40960
    v_exp_f32 v74, v74
    v_mfma_f32_16x16x32_bf16 v[88:91], a[112:115], a[56:59], v[88:91]
    v_exp_f32 v75, v75
    buffer_load_dwordx4 v201, s[16:19], s45 offen offset:1024 nt lds
    v_mfma_f32_16x16x32_bf16 v[84:87], a[116:119], a[48:51], v[84:87]
    ds_read_b128 a[80:83], v194 offset:32768
    v_cvt_pk_bf16_f32 v164, v72, v73
    v_mfma_f32_16x16x32_bf16 v[92:95], a[116:119], a[56:59], v[92:95]
    v_exp_f32 v76, v76
    s_waitcnt lgkmcnt(13)
    v_mfma_f32_16x16x32_bf16 v[80:83], a[120:123], a[52:55], v[80:83]
    ds_read_b128 a[84:87], v194 offset:40960
    v_exp_f32 v77, v77
    v_mfma_f32_16x16x32_bf16 v[88:91], a[120:123], a[60:63], v[88:91]
    v_cvt_pk_bf16_f32 v165, v74, v75
    buffer_load_dwordx4 v202, s[16:19], s45 offen offset:2048 nt lds
    v_mfma_f32_16x16x32_bf16 v[84:87], a[124:127], a[52:55], v[84:87]
    ds_read_b128 a[88:91], v195 offset:32768
    v_exp_f32 v78, v78
    v_mfma_f32_16x16x32_bf16 v[92:95], a[124:127], a[60:63], v[92:95]
    v_exp_f32 v79, v79
    s_waitcnt lgkmcnt(5)
    v_mfma_f32_16x16x32_bf16 v[96:99], a[64:67], a[0:3], v[242:245]
    ds_read_b128 a[92:95], v195 offset:40960
    v_cvt_pk_bf16_f32 v166, v76, v77
    v_mfma_f32_16x16x32_bf16 v[104:107], a[64:67], a[8:11], v[246:249]
    v_cvt_pk_bf16_f32 v167, v78, v79
    buffer_load_dwordx4 v203, s[16:19], s45 offen offset:3072 nt lds
    v_mfma_f32_16x16x32_bf16 v[100:103], a[68:71], a[0:3], v[242:245]
    ds_read_b128 a[96:99], v192 offset:33024
    v_max3_f32 v238, v80, v81, v82
    v_mfma_f32_16x16x32_bf16 v[108:111], a[68:71], a[8:11], v[246:249]
    v_max3_f32 v239, v88, v89, v90
    v_max3_f32 v238, v238, v83, v84
    s_waitcnt lgkmcnt(5)
    v_mfma_f32_16x16x32_bf16 v[96:99], a[72:75], a[4:7], v[96:99]
    ds_read_b128 a[100:103], v192 offset:41216
    v_max3_f32 v239, v239, v91, v92
    v_mfma_f32_16x16x32_bf16 v[104:107], a[72:75], a[12:15], v[104:107]
    v_max3_f32 v238, v238, v85, v86
    v_mfma_f32_16x16x32_bf16 v[100:103], a[76:79], a[4:7], v[100:103]
    ds_read_b128 a[104:107], v193 offset:33024
    v_max3_f32 v239, v239, v93, v94
    v_mfma_f32_16x16x32_bf16 v[108:111], a[76:79], a[12:15], v[108:111]
    v_max_f32 v238, v238, v87
    s_waitcnt lgkmcnt(5)
    v_mfma_f32_16x16x32_bf16 v[96:99], a[80:83], a[16:19], v[96:99]
    ds_read_b128 a[108:111], v193 offset:41216
    v_max_f32 v239, v239, v95
    v_mfma_f32_16x16x32_bf16 v[104:107], a[80:83], a[24:27], v[104:107]
    v_max_f32 v240, v238, v239
    v_mfma_f32_16x16x32_bf16 v[100:103], a[84:87], a[16:19], v[100:103]
    ds_read_b128 a[112:115], v194 offset:33024
    v_cmp_lt_f32 vcc, s50, v240
    s_nop 0
    s_cbranch_vccnz L32
L33:
    v_mfma_f32_16x16x32_bf16 v[108:111], a[84:87], a[24:27], v[108:111]
    v_exp_f32 v80, v80
    s_waitcnt lgkmcnt(5)
    v_mfma_f32_16x16x32_bf16 v[96:99], a[88:91], a[20:23], v[96:99]
    ds_read_b128 a[116:119], v194 offset:41216
    v_exp_f32 v81, v81
    v_mfma_f32_16x16x32_bf16 v[104:107], a[88:91], a[28:31], v[104:107]
    v_exp_f32 v82, v82
    v_mfma_f32_16x16x32_bf16 v[100:103], a[92:95], a[20:23], v[100:103]
    ds_read_b128 a[120:123], v195 offset:33024
    v_exp_f32 v83, v83
    v_mfma_f32_16x16x32_bf16 v[108:111], a[92:95], a[28:31], v[108:111]
    v_cvt_pk_bf16_f32 v168, v80, v81
    s_waitcnt lgkmcnt(5)
    v_mfma_f32_16x16x32_bf16 v[96:99], a[96:99], a[32:35], v[96:99]
    ds_read_b128 a[124:127], v195 offset:41216
    v_exp_f32 v84, v84
    v_mfma_f32_16x16x32_bf16 v[104:107], a[96:99], a[40:43], v[104:107]
    v_exp_f32 v85, v85
    v_mfma_f32_16x16x32_bf16 v[100:103], a[100:103], a[32:35], v[100:103]
    s_waitcnt vmcnt(9)
    s_barrier
    ds_read_b128 a[64:67], v192 offset:49152
    v_cvt_pk_bf16_f32 v169, v82, v83
    v_mfma_f32_16x16x32_bf16 v[108:111], a[100:103], a[40:43], v[108:111]
    v_exp_f32 v86, v86
    v_exp_f32 v87, v87
    s_waitcnt lgkmcnt(5)
    v_mfma_f32_16x16x32_bf16 v[96:99], a[104:107], a[36:39], v[96:99]
    ds_read_b128 a[68:71], v192 offset:57344
    v_cvt_pk_bf16_f32 v170, v84, v85
    v_mfma_f32_16x16x32_bf16 v[104:107], a[104:107], a[44:47], v[104:107]
    v_exp_f32 v88, v88
    v_mfma_f32_16x16x32_bf16 v[100:103], a[108:111], a[36:39], v[100:103]
    ds_read_b128 a[72:75], v193 offset:49152
    v_exp_f32 v89, v89
    v_mfma_f32_16x16x32_bf16 v[108:111], a[108:111], a[44:47], v[108:111]
    v_cvt_pk_bf16_f32 v171, v86, v87
    s_add_u32 m0, s41, 147456
    s_xor_b32 s45, s52, 65664
    buffer_load_dwordx4 v200, s[16:19], s45 offen offset:0 nt lds
    s_waitcnt lgkmcnt(5)
    v_mfma_f32_16x16x32_bf16 v[96:99], a[112:115], a[48:51], v[96:99]
    ds_read_b128 a[76:79], v193 offset:57344
    v_exp_f32 v90, v90
    v_mfma_f32_16x16x32_bf16 v[104:107], a[112:115], a[56:59], v[104:107]
    v_exp_f32 v91, v91
    v_mfma_f32_16x16x32_bf16 v[100:103], a[116:119], a[48:51], v[100:103]
    ds_read_b128 a[80:83], v194 offset:49152
    v_cvt_pk_bf16_f32 v172, v88, v89
    v_mfma_f32_16x16x32_bf16 v[108:111], a[116:119], a[56:59], v[108:111]
    v_exp_f32 v92, v92
    buffer_load_dwordx4 v201, s[16:19], s45 offen offset:1024 nt lds
    s_waitcnt lgkmcnt(5)
    v_mfma_f32_16x16x32_bf16 v[96:99], a[120:123], a[52:55], v[96:99]
    ds_read_b128 a[84:87], v194 offset:57344
    v_exp_f32 v93, v93
    v_mfma_f32_16x16x32_bf16 v[104:107], a[120:123], a[60:63], v[104:107]
    v_cvt_pk_bf16_f32 v173, v90, v91
    v_mfma_f32_16x16x32_bf16 v[100:103], a[124:127], a[52:55], v[100:103]
    ds_read_b128 a[88:91], v195 offset:49152
    v_exp_f32 v94, v94
    v_mfma_f32_16x16x32_bf16 v[108:111], a[124:127], a[60:63], v[108:111]
    v_exp_f32 v95, v95
    buffer_load_dwordx4 v202, s[16:19], s45 offen offset:2048 nt lds
    s_waitcnt lgkmcnt(5)
    v_mfma_f32_16x16x32_bf16 v[112:115], a[64:67], a[0:3], v[242:245]
    ds_read_b128 a[92:95], v195 offset:57344
    v_cvt_pk_bf16_f32 v174, v92, v93
    v_mfma_f32_16x16x32_bf16 v[120:123], a[64:67], a[8:11], v[246:249]
    v_cvt_pk_bf16_f32 v175, v94, v95
    v_mfma_f32_16x16x32_bf16 v[116:119], a[68:71], a[0:3], v[242:245]
    ds_read_b128 a[96:99], v192 offset:49408
    v_max3_f32 v238, v96, v97, v98
    v_max3_f32 v239, v104, v105, v106
    v_mfma_f32_16x16x32_bf16 v[124:127], a[68:71], a[8:11], v[246:249]
    v_max3_f32 v238, v238, v99, v100
    buffer_load_dwordx4 v203, s[16:19], s45 offen offset:3072 nt lds
    s_waitcnt lgkmcnt(5)
    v_mfma_f32_16x16x32_bf16 v[112:115], a[72:75], a[4:7], v[112:115]
    ds_read_b128 a[100:103], v192 offset:57600
    v_max3_f32 v239, v239, v107, v108
    v_mfma_f32_16x16x32_bf16 v[120:123], a[72:75], a[12:15], v[120:123]
    v_max3_f32 v238, v238, v101, v102
    v_mfma_f32_16x16x32_bf16 v[116:119], a[76:79], a[4:7], v[116:119]
    ds_read_b128 a[104:107], v193 offset:49408
    v_max3_f32 v239, v239, v109, v110
    v_mfma_f32_16x16x32_bf16 v[124:127], a[76:79], a[12:15], v[124:127]
    v_max_f32 v238, v238, v103
    s_add_u32 m0, s41, 81920
    s_xor_b32 s49, s5, 5
    s_mul_i32 s49, s49, 57344
    s_add_u32 s49, s49, s47
    buffer_load_dwordx4 v204, s[24:27], s49 offen offset:0  lds
    s_waitcnt lgkmcnt(5)
    v_mfma_f32_16x16x32_bf16 v[112:115], a[80:83], a[16:19], v[112:115]
    ds_read_b128 a[108:111], v193 offset:57600
    v_max_f32 v239, v239, v111
    v_mfma_f32_16x16x32_bf16 v[120:123], a[80:83], a[24:27], v[120:123]
    v_max_f32 v240, v238, v239
    v_cmp_lt_f32 vcc, s50, v240
    s_nop 0
    s_cbranch_vccnz L34
L35:
    v_mfma_f32_16x16x32_bf16 v[116:119], a[84:87], a[16:19], v[116:119]
    ds_read_b128 a[112:115], v194 offset:49408
    v_exp_f32 v96, v96
    v_mfma_f32_16x16x32_bf16 v[124:127], a[84:87], a[24:27], v[124:127]
    v_exp_f32 v97, v97
    buffer_load_dwordx4 v205, s[24:27], s49 offen offset:1024  lds
    s_waitcnt lgkmcnt(5)
    v_mfma_f32_16x16x32_bf16 v[112:115], a[88:91], a[20:23], v[112:115]
    ds_read_b128 a[116:119], v194 offset:57600
    v_exp_f32 v98, v98
    v_mfma_f32_16x16x32_bf16 v[120:123], a[88:91], a[28:31], v[120:123]
    v_exp_f32 v99, v99
    v_mfma_f32_16x16x32_bf16 v[116:119], a[92:95], a[20:23], v[116:119]
    ds_read_b128 a[120:123], v195 offset:49408
    v_cvt_pk_bf16_f32 v176, v96, v97
    v_mfma_f32_16x16x32_bf16 v[124:127], a[92:95], a[28:31], v[124:127]
    v_exp_f32 v100, v100
    buffer_load_dwordx4 v206, s[24:27], s49 offen offset:2048  lds
    s_waitcnt lgkmcnt(5)
    v_mfma_f32_16x16x32_bf16 v[112:115], a[96:99], a[32:35], v[112:115]
    ds_read_b128 a[124:127], v195 offset:57600
    v_exp_f32 v101, v101
    v_mfma_f32_16x16x32_bf16 v[120:123], a[96:99], a[40:43], v[120:123]
    v_cvt_pk_bf16_f32 v177, v98, v99
    v_exp_f32 v102, v102
    v_mfma_f32_16x16x32_bf16 v[116:119], a[100:103], a[32:35], v[116:119]
    v_exp_f32 v103, v103
    v_mfma_f32_16x16x32_bf16 v[124:127], a[100:103], a[40:43], v[124:127]
    v_cvt_pk_bf16_f32 v178, v100, v101
    buffer_load_dwordx4 v207, s[24:27], s49 offen offset:3072  lds
    s_waitcnt lgkmcnt(4)
    v_mfma_f32_16x16x32_bf16 v[112:115], a[104:107], a[36:39], v[112:115]
    v_exp_f32 v104, v104
    v_mfma_f32_16x16x32_bf16 v[120:123], a[104:107], a[44:47], v[120:123]
    v_exp_f32 v105, v105
    buffer_load_dword v237, v236, s[36:39], 0 offen sc1
    v_mfma_f32_16x16x32_bf16 v[116:119], a[108:111], a[36:39], v[116:119]
    v_cvt_pk_bf16_f32 v179, v102, v103
    v_mfma_f32_16x16x32_bf16 v[124:127], a[108:111], a[44:47], v[124:127]
    v_exp_f32 v106, v106
    s_waitcnt lgkmcnt(2)
    v_mfma_f32_16x16x32_bf16 v[112:115], a[112:115], a[48:51], v[112:115]
    v_exp_f32 v107, v107
    v_mfma_f32_16x16x32_bf16 v[120:123], a[112:115], a[56:59], v[120:123]
    v_cvt_pk_bf16_f32 v180, v104, v105
    v_exp_f32 v108, v108
    v_mfma_f32_16x16x32_bf16 v[116:119], a[116:119], a[48:51], v[116:119]
    v_exp_f32 v109, v109
    v_mfma_f32_16x16x32_bf16 v[124:127], a[116:119], a[56:59], v[124:127]
    v_cvt_pk_bf16_f32 v181, v106, v107
    s_waitcnt lgkmcnt(0)
    v_mfma_f32_16x16x32_bf16 v[112:115], a[120:123], a[52:55], v[112:115]
    v_exp_f32 v110, v110
    v_mfma_f32_16x16x32_bf16 v[120:123], a[120:123], a[60:63], v[120:123]
    v_exp_f32 v111, v111
    v_mfma_f32_16x16x32_bf16 v[116:119], a[124:127], a[52:55], v[116:119]
    v_cvt_pk_bf16_f32 v182, v108, v109
    v_mfma_f32_16x16x32_bf16 v[124:127], a[124:127], a[60:63], v[124:127]
    v_cvt_pk_bf16_f32 v183, v110, v111
    v_mov_b32 v254, 0x3f803f80
    v_accvgpr_write_b32 a0, v254
    v_accvgpr_write_b32 a1, v254
    v_accvgpr_write_b32 a2, v254
    v_accvgpr_write_b32 a3, v254
    v_max3_f32 v238, v112, v113, v114
    v_max3_f32 v239, v120, v121, v122
    v_max3_f32 v238, v238, v115, v116
    v_max3_f32 v239, v239, v123, v124
    v_max3_f32 v238, v238, v117, v118
    v_max3_f32 v239, v239, v125, v126
    v_max_f32 v238, v238, v119
    v_max_f32 v239, v239, v127
    v_max_f32 v240, v238, v239
    v_cmp_lt_f32 vcc, s50, v240
    s_nop 0
    s_cbranch_vccnz L36
L37:
    s_waitcnt vmcnt(9)
    s_barrier
    ds_read_b64_tr_b16 a[160:161], v224 offset:0
    ds_read_b64_tr_b16 a[162:163], v224 offset:4096
    ds_read_b64_tr_b16 a[164:165], v225 offset:0
    ds_read_b64_tr_b16 a[166:167], v225 offset:4096
    ds_read_b64_tr_b16 a[168:169], v224 offset:8192
    ds_read_b64_tr_b16 a[170:171], v224 offset:12288
    ds_read_b64_tr_b16 a[172:173], v225 offset:8192
    ds_read_b64_tr_b16 a[174:175], v225 offset:12288
    ds_read_b64_tr_b16 a[64:65], v212 offset:0
    ds_read_b64_tr_b16 a[66:67], v212 offset:2048
    ds_read_b64_tr_b16 a[68:69], v213 offset:0
    ds_read_b64_tr_b16 a[70:71], v213 offset:2048
    ds_read_b64_tr_b16 a[72:73], v214 offset:0
    ds_read_b64_tr_b16 a[74:75], v214 offset:2048
    ds_read_b64_tr_b16 a[76:77], v215 offset:0
    ds_read_b64_tr_b16 a[78:79], v215 offset:2048
    ds_read_b64_tr_b16 a[80:81], v212 offset:4096
    ds_read_b64_tr_b16 a[82:83], v212 offset:6144
    s_waitcnt lgkmcnt(8)
    v_mfma_f32_16x16x32_bf16 v[0:3], a[64:67], v[128:131], 0
    ds_read_b64_tr_b16 a[84:85], v213 offset:4096
    ds_read_b64_tr_b16 a[86:87], v213 offset:6144
    s_add_u32 m0, s41, 98304
    s_xor_b32 s45, s52, 256
    buffer_load_dwordx4 v200, s[16:19], s45 offen offset:0 nt lds
    v_mfma_f32_16x16x32_bf16 v[16:19], a[64:67], v[132:135], 0
    v_exp_f32 v112, v112
    v_mfma_f32_16x16x32_bf16 v[56:59], a[0:3], v[128:131], 0
    v_exp_f32 v113, v113
    s_waitcnt lgkmcnt(8)
    v_mfma_f32_16x16x32_bf16 v[4:7], a[68:71], v[128:131], 0
    ds_read_b64_tr_b16 a[88:89], v214 offset:4096
    ds_read_b64_tr_b16 a[90:91], v214 offset:6144
    v_mfma_f32_16x16x32_bf16 v[20:23], a[68:71], v[132:135], 0
    v_mfma_f32_16x16x32_bf16 v[60:63], a[0:3], v[132:135], 0
    v_exp_f32 v114, v114
    s_waitcnt lgkmcnt(8)
    v_mfma_f32_16x16x32_bf16 v[8:11], a[72:75], v[128:131], 0
    ds_read_b64_tr_b16 a[92:93], v215 offset:4096
    ds_read_b64_tr_b16 a[94:95], v215 offset:6144
    buffer_load_dwordx4 v201, s[16:19], s45 offen offset:1024 nt lds
    v_mfma_f32_16x16x32_bf16 v[24:27], a[72:75], v[132:135], 0
    v_exp_f32 v115, v115
    s_waitcnt lgkmcnt(8)
    v_mfma_f32_16x16x32_bf16 v[12:15], a[76:79], v[128:131], 0
    ds_read_b64_tr_b16 a[96:97], v212 offset:8192
    ds_read_b64_tr_b16 a[98:99], v212 offset:10240
    v_mfma_f32_16x16x32_bf16 v[28:31], a[76:79], v[132:135], 0
    v_cvt_pk_bf16_f32 v184, v112, v113
    s_waitcnt lgkmcnt(8)
    v_mfma_f32_16x16x32_bf16 v[0:3], a[80:83], v[136:139], v[0:3]
    ds_read_b64_tr_b16 a[100:101], v213 offset:8192
    ds_read_b64_tr_b16 a[102:103], v213 offset:10240
    v_mfma_f32_16x16x32_bf16 v[16:19], a[80:83], v[140:143], v[16:19]
    buffer_load_dwordx4 v202, s[16:19], s45 offen offset:2048 nt lds
    v_mfma_f32_16x16x32_bf16 v[56:59], a[0:3], v[136:139], v[56:59]
    v_exp_f32 v116, v116
    s_waitcnt lgkmcnt(8)
    v_mfma_f32_16x16x32_bf16 v[4:7], a[84:87], v[136:139], v[4:7]
    ds_read_b64_tr_b16 a[104:105], v214 offset:8192
    ds_read_b64_tr_b16 a[106:107], v214 offset:10240
    v_mfma_f32_16x16x32_bf16 v[20:23], a[84:87], v[140:143], v[20:23]
    v_mfma_f32_16x16x32_bf16 v[60:63], a[0:3], v[140:143], v[60:63]
    v_exp_f32 v117, v117
    s_waitcnt lgkmcnt(8)
    v_mfma_f32_16x16x32_bf16 v[8:11], a[88:91], v[136:139], v[8:11]
    ds_read_b64_tr_b16 a[108:109], v215 offset:8192
    ds_read_b64_tr_b16 a[110:111], v215 offset:10240
    buffer_load_dwordx4 v203, s[16:19], s45 offen offset:3072 nt lds
    v_mfma_f32_16x16x32_bf16 v[24:27], a[88:91], v[140:143], v[24:27]
    v_cvt_pk_bf16_f32 v185, v114, v115
    s_waitcnt lgkmcnt(8)
    v_mfma_f32_16x16x32_bf16 v[12:15], a[92:95], v[136:139], v[12:15]
    ds_read_b64_tr_b16 a[112:113], v212 offset:12288
    ds_read_b64_tr_b16 a[114:115], v212 offset:14336
    v_exp_f32 v118, v118
    v_mfma_f32_16x16x32_bf16 v[28:31], a[92:95], v[140:143], v[28:31]
    v_exp_f32 v119, v119
    s_waitcnt lgkmcnt(8)
    v_mfma_f32_16x16x32_bf16 v[0:3], a[96:99], v[144:147], v[0:3]
    ds_read_b64_tr_b16 a[116:117], v213 offset:12288
    ds_read_b64_tr_b16 a[118:119], v213 offset:14336
    v_mfma_f32_16x16x32_bf16 v[16:19], a[96:99], v[148:151], v[16:19]
    v_mfma_f32_16x16x32_bf16 v[56:59], a[0:3], v[144:147], v[56:59]
    v_cvt_pk_bf16_f32 v186, v116, v117
    s_waitcnt lgkmcnt(8)
    v_mfma_f32_16x16x32_bf16 v[4:7], a[100:103], v[144:147], v[4:7]
    ds_read_b64_tr_b16 a[120:121], v214 offset:12288
    ds_read_b64_tr_b16 a[122:123], v214 offset:14336
    v_mfma_f32_16x16x32_bf16 v[20:23], a[100:103], v[148:151], v[20:23]
    v_mfma_f32_16x16x32_bf16 v[60:63], a[0:3], v[148:151], v[60:63]
    v_exp_f32 v120, v120
    s_waitcnt lgkmcnt(8)
    v_mfma_f32_16x16x32_bf16 v[8:11], a[104:107], v[144:147], v[8:11]
    ds_read_b64_tr_b16 a[124:125], v215 offset:12288
    ds_read_b64_tr_b16 a[126:127], v215 offset:14336
    v_mfma_f32_16x16x32_bf16 v[24:27], a[104:107], v[148:151], v[24:27]
    v_exp_f32 v121, v121
    s_waitcnt lgkmcnt(8)
    v_mfma_f32_16x16x32_bf16 v[12:15], a[108:111], v[144:147], v[12:15]
    s_waitcnt vmcnt(9)
    s_barrier
    ds_read_b64_tr_b16 a[64:65], v216 offset:16384
    ds_read_b64_tr_b16 a[66:67], v216 offset:18432
    v_mfma_f32_16x16x32_bf16 v[28:31], a[108:111], v[148:151], v[28:31]
    v_cvt_pk_bf16_f32 v187, v118, v119
    s_waitcnt lgkmcnt(8)
    v_mfma_f32_16x16x32_bf16 v[0:3], a[112:115], v[152:155], v[0:3]
    ds_read_b64_tr_b16 a[68:69], v217 offset:16384
    ds_read_b64_tr_b16 a[70:71], v217 offset:18432
    v_mfma_f32_16x16x32_bf16 v[16:19], a[112:115], v[156:159], v[16:19]
    s_add_u32 m0, s41, 131072
    s_xor_b32 s45, s52, 65792
    buffer_load_dwordx4 v200, s[16:19], s45 offen offset:0 nt lds
    v_mfma_f32_16x16x32_bf16 v[56:59], a[0:3], v[152:155], v[56:59]
    v_exp_f32 v122, v122
    s_waitcnt lgkmcnt(8)
    v_mfma_f32_16x16x32_bf16 v[4:7], a[116:119], v[152:155], v[4:7]
    ds_read_b64_tr_b16 a[72:73], v216 offset:20480
    ds_read_b64_tr_b16 a[74:75], v216 offset:22528
    v_mfma_f32_16x16x32_bf16 v[20:23], a[116:119], v[156:159], v[20:23]
    v_mfma_f32_16x16x32_bf16 v[60:63], a[0:3], v[156:159], v[60:63]
    v_exp_f32 v123, v123
    s_waitcnt lgkmcnt(8)
    v_mfma_f32_16x16x32_bf16 v[8:11], a[120:123], v[152:155], v[8:11]
    ds_read_b64_tr_b16 a[76:77], v217 offset:20480
    ds_read_b64_tr_b16 a[78:79], v217 offset:22528
    buffer_load_dwordx4 v201, s[16:19], s45 offen offset:1024 nt lds
    v_mfma_f32_16x16x32_bf16 v[24:27], a[120:123], v[156:159], v[24:27]
    v_cvt_pk_bf16_f32 v188, v120, v121
    v_exp_f32 v124, v124
    s_waitcnt lgkmcnt(8)
    v_mfma_f32_16x16x32_bf16 v[12:15], a[124:127], v[152:155], v[12:15]
    ds_read_b64_tr_b16 a[80:81], v216 offset:24576
    ds_read_b64_tr_b16 a[82:83], v216 offset:26624
    v_mfma_f32_16x16x32_bf16 v[28:31], a[124:127], v[156:159], v[28:31]
    v_exp_f32 v125, v125
    s_waitcnt lgkmcnt(8)
    v_mfma_f32_16x16x32_bf16 v[0:3], a[64:67], v[160:163], v[0:3]
    ds_read_b64_tr_b16 a[84:85], v217 offset:24576
    ds_read_b64_tr_b16 a[86:87], v217 offset:26624
    v_mfma_f32_16x16x32_bf16 v[16:19], a[64:67], v[164:167], v[16:19]
    buffer_load_dwordx4 v202, s[16:19], s45 offen offset:2048 nt lds
    v_mfma_f32_16x16x32_bf16 v[56:59], a[0:3], v[160:163], v[56:59]
    v_cvt_pk_bf16_f32 v189, v122, v123
    s_waitcnt lgkmcnt(8)
    v_mfma_f32_16x16x32_bf16 v[4:7], a[68:71], v[160:163], v[4:7]
    ds_read_b64_tr_b16 a[88:89], v216 offset:28672
    ds_read_b64_tr_b16 a[90:91], v216 offset:30720
    v_mfma_f32_16x16x32_bf16 v[20:23], a[68:71], v[164:167], v[20:23]
    v_mfma_f32_16x16x32_bf16 v[60:63], a[0:3], v[164:167], v[60:63]
    v_exp_f32 v126, v126
    s_waitcnt lgkmcnt(8)
    v_mfma_f32_16x16x32_bf16 v[0:3], a[72:75], v[168:171], v[0:3]
    ds_read_b64_tr_b16 a[92:93], v217 offset:28672
    ds_read_b64_tr_b16 a[94:95], v217 offset:30720
    v_mfma_f32_16x16x32_bf16 v[16:19], a[72:75], v[172:175], v[16:19]
    buffer_load_dwordx4 v203, s[16:19], s45 offen offset:3072 nt lds
    v_mfma_f32_16x16x32_bf16 v[56:59], a[0:3], v[168:171], v[56:59]
    v_exp_f32 v127, v127
    s_waitcnt lgkmcnt(8)
    v_mfma_f32_16x16x32_bf16 v[4:7], a[76:79], v[168:171], v[4:7]
    ds_read_b64_tr_b16 a[96:97], v218 offset:16384
    ds_read_b64_tr_b16 a[98:99], v218 offset:18432
    v_mfma_f32_16x16x32_bf16 v[20:23], a[76:79], v[172:175], v[20:23]
    v_mfma_f32_16x16x32_bf16 v[60:63], a[0:3], v[172:175], v[60:63]
    v_cvt_pk_bf16_f32 v190, v124, v125
    s_waitcnt lgkmcnt(8)
    v_mfma_f32_16x16x32_bf16 v[0:3], a[80:83], v[176:179], v[0:3]
    ds_read_b64_tr_b16 a[100:101], v219 offset:16384
    ds_read_b64_tr_b16 a[102:103], v219 offset:18432
    v_mfma_f32_16x16x32_bf16 v[16:19], a[80:83], v[180:183], v[16:19]
    v_mfma_f32_16x16x32_bf16 v[56:59], a[0:3], v[176:179], v[56:59]
    v_cvt_pk_bf16_f32 v191, v126, v127
    s_waitcnt lgkmcnt(8)
    v_mfma_f32_16x16x32_bf16 v[4:7], a[84:87], v[176:179], v[4:7]
    ds_read_b64_tr_b16 a[104:105], v218 offset:20480
    ds_read_b64_tr_b16 a[106:107], v218 offset:22528
    v_mfma_f32_16x16x32_bf16 v[20:23], a[84:87], v[180:183], v[20:23]
    v_mfma_f32_16x16x32_bf16 v[60:63], a[0:3], v[180:183], v[60:63]
    s_waitcnt lgkmcnt(8)
    v_mfma_f32_16x16x32_bf16 v[0:3], a[88:91], v[184:187], v[0:3]
    ds_read_b64_tr_b16 a[108:109], v219 offset:20480
    ds_read_b64_tr_b16 a[110:111], v219 offset:22528
    v_mfma_f32_16x16x32_bf16 v[16:19], a[88:91], v[188:191], v[16:19]
    v_mfma_f32_16x16x32_bf16 v[56:59], a[0:3], v[184:187], v[56:59]
    s_waitcnt lgkmcnt(8)
    v_mfma_f32_16x16x32_bf16 v[4:7], a[92:95], v[184:187], v[4:7]
    ds_read_b64_tr_b16 a[112:113], v218 offset:24576
    ds_read_b64_tr_b16 a[114:115], v218 offset:26624
    v_mfma_f32_16x16x32_bf16 v[20:23], a[92:95], v[188:191], v[20:23]
    v_mfma_f32_16x16x32_bf16 v[60:63], a[0:3], v[188:191], v[60:63]
    s_waitcnt lgkmcnt(8)
    v_mfma_f32_16x16x32_bf16 v[8:11], a[96:99], v[160:163], v[8:11]
    ds_read_b64_tr_b16 a[116:117], v219 offset:24576
    ds_read_b64_tr_b16 a[118:119], v219 offset:26624
    v_mfma_f32_16x16x32_bf16 v[24:27], a[96:99], v[164:167], v[24:27]
    s_waitcnt lgkmcnt(8)
    v_mfma_f32_16x16x32_bf16 v[12:15], a[100:103], v[160:163], v[12:15]
    ds_read_b64_tr_b16 a[120:121], v218 offset:28672
    ds_read_b64_tr_b16 a[122:123], v218 offset:30720
    s_waitcnt vmcnt(8)
    v_cmp_gt_u32 vcc, 3, v237
    s_mov_b32 s51, 0
    s_cbranch_vccnz L40
L41:
    v_mfma_f32_16x16x32_bf16 v[28:31], a[100:103], v[164:167], v[28:31]
    v_mov_b32 v230, v56
    s_waitcnt lgkmcnt(8)
    v_mfma_f32_16x16x32_bf16 v[8:11], a[104:107], v[168:171], v[8:11]
    ds_read_b64_tr_b16 a[124:125], v219 offset:28672
    ds_read_b64_tr_b16 a[126:127], v219 offset:30720
    v_mov_b32 v231, v60
    v_mfma_f32_16x16x32_bf16 v[24:27], a[104:107], v[172:175], v[24:27]
    buffer_store_dwordx4 v[228:231], v253, s[36:39], s56 offen
    s_waitcnt lgkmcnt(8)
    v_mfma_f32_16x16x32_bf16 v[12:15], a[108:111], v[168:171], v[12:15]
    v_cvt_pk_bf16_f32 v64, v0, v1
    v_mfma_f32_16x16x32_bf16 v[28:31], a[108:111], v[172:175], v[28:31]
    v_cvt_pk_bf16_f32 v65, v2, v3
    s_waitcnt lgkmcnt(6)
    v_mfma_f32_16x16x32_bf16 v[8:11], a[112:115], v[176:179], v[8:11]
    v_cvt_pk_bf16_f32 v66, v4, v5
    v_mfma_f32_16x16x32_bf16 v[24:27], a[112:115], v[180:183], v[24:27]
    v_cvt_pk_bf16_f32 v67, v6, v7
    s_waitcnt lgkmcnt(4)
    v_mfma_f32_16x16x32_bf16 v[12:15], a[116:119], v[176:179], v[12:15]
    buffer_store_dwordx4 v[64:67], v234, s[36:39], s56 offen offset:0
    v_mfma_f32_16x16x32_bf16 v[28:31], a[116:119], v[180:183], v[28:31]
    v_cvt_pk_bf16_f32 v72, v16, v17
    s_waitcnt lgkmcnt(2)
    v_mfma_f32_16x16x32_bf16 v[8:11], a[120:123], v[184:187], v[8:11]
    v_cvt_pk_bf16_f32 v73, v18, v19
    v_mfma_f32_16x16x32_bf16 v[24:27], a[120:123], v[188:191], v[24:27]
    v_cvt_pk_bf16_f32 v74, v20, v21
    s_waitcnt lgkmcnt(0)
    v_mfma_f32_16x16x32_bf16 v[12:15], a[124:127], v[184:187], v[12:15]
    v_cvt_pk_bf16_f32 v75, v22, v23
    v_mfma_f32_16x16x32_bf16 v[28:31], a[124:127], v[188:191], v[28:31]
    buffer_store_dwordx4 v[72:75], v234, s[36:39], s56 offen offset:2048
    v_cvt_pk_bf16_f32 v68, v8, v9
    v_cvt_pk_bf16_f32 v69, v10, v11
    s_nop 2
    v_cvt_pk_bf16_f32 v70, v12, v13
    v_cvt_pk_bf16_f32 v71, v14, v15
    buffer_store_dwordx4 v[68:71], v234, s[36:39], s56 offen offset:1024
    v_cvt_pk_bf16_f32 v76, v24, v25
    v_cvt_pk_bf16_f32 v77, v26, v27
    v_cvt_pk_bf16_f32 v78, v28, v29
    v_cvt_pk_bf16_f32 v79, v30, v31
    buffer_store_dwordx4 v[76:79], v234, s[36:39], s56 offen offset:3072
    s_waitcnt vmcnt(9)
    s_barrier
    ds_read_b64_tr_b16 a[176:177], v222 offset:16384
    ds_read_b64_tr_b16 a[178:179], v222 offset:20480
    ds_read_b64_tr_b16 a[180:181], v223 offset:16384
    ds_read_b64_tr_b16 a[182:183], v223 offset:20480
    ds_read_b64_tr_b16 a[184:185], v222 offset:24576
    ds_read_b64_tr_b16 a[186:187], v222 offset:28672
    ds_read_b64_tr_b16 a[188:189], v223 offset:24576
    ds_read_b64_tr_b16 a[190:191], v223 offset:28672
    ds_read_b64_tr_b16 a[64:65], v212 offset:32768
    ds_read_b64_tr_b16 a[66:67], v212 offset:34816
    ds_read_b64_tr_b16 a[68:69], v213 offset:32768
    ds_read_b64_tr_b16 a[70:71], v213 offset:34816
    ds_read_b64_tr_b16 a[72:73], v214 offset:32768
    ds_read_b64_tr_b16 a[74:75], v214 offset:34816
    ds_read_b64_tr_b16 a[76:77], v215 offset:32768
    ds_read_b64_tr_b16 a[78:79], v215 offset:34816
    ds_read_b64_tr_b16 a[80:81], v212 offset:36864
    ds_read_b64_tr_b16 a[82:83], v212 offset:38912
    s_waitcnt lgkmcnt(8)
    v_mfma_f32_16x16x32_bf16 v[32:35], a[64:67], v[128:131], 0
    ds_read_b64_tr_b16 a[84:85], v213 offset:36864
    ds_read_b64_tr_b16 a[86:87], v213 offset:38912
    v_mfma_f32_16x16x32_bf16 v[48:51], a[64:67], v[132:135], 0
    s_add_u32 m0, s41, 0
    s_xor_b32 s45, s52, 384
    buffer_load_dwordx4 v200, s[16:19], s45 offen offset:0 nt lds
    s_waitcnt lgkmcnt(8)
    v_mfma_f32_16x16x32_bf16 v[36:39], a[68:71], v[128:131], 0
    ds_read_b64_tr_b16 a[88:89], v214 offset:36864
    ds_read_b64_tr_b16 a[90:91], v214 offset:38912
    v_mfma_f32_16x16x32_bf16 v[52:55], a[68:71], v[132:135], 0
    s_waitcnt lgkmcnt(8)
    v_mfma_f32_16x16x32_bf16 v[40:43], a[72:75], v[128:131], 0
    ds_read_b64_tr_b16 a[92:93], v215 offset:36864
    ds_read_b64_tr_b16 a[94:95], v215 offset:38912
    v_mfma_f32_16x16x32_bf16 v[56:59], a[72:75], v[132:135], 0
    buffer_load_dwordx4 v201, s[16:19], s45 offen offset:1024 nt lds
    s_waitcnt lgkmcnt(8)
    v_mfma_f32_16x16x32_bf16 v[44:47], a[76:79], v[128:131], 0
    ds_read_b64_tr_b16 a[96:97], v212 offset:40960
    ds_read_b64_tr_b16 a[98:99], v212 offset:43008
    v_mfma_f32_16x16x32_bf16 v[60:63], a[76:79], v[132:135], 0
    s_waitcnt lgkmcnt(8)
    v_mfma_f32_16x16x32_bf16 v[32:35], a[80:83], v[136:139], v[32:35]
    ds_read_b64_tr_b16 a[100:101], v213 offset:40960
    ds_read_b64_tr_b16 a[102:103], v213 offset:43008
    v_mfma_f32_16x16x32_bf16 v[48:51], a[80:83], v[140:143], v[48:51]
    buffer_load_dwordx4 v202, s[16:19], s45 offen offset:2048 nt lds
    s_waitcnt lgkmcnt(8)
    v_mfma_f32_16x16x32_bf16 v[36:39], a[84:87], v[136:139], v[36:39]
    ds_read_b64_tr_b16 a[104:105], v214 offset:40960
    ds_read_b64_tr_b16 a[106:107], v214 offset:43008
    v_mfma_f32_16x16x32_bf16 v[52:55], a[84:87], v[140:143], v[52:55]
    s_waitcnt lgkmcnt(8)
    v_mfma_f32_16x16x32_bf16 v[40:43], a[88:91], v[136:139], v[40:43]
    ds_read_b64_tr_b16 a[108:109], v215 offset:40960
    ds_read_b64_tr_b16 a[110:111], v215 offset:43008
    v_mfma_f32_16x16x32_bf16 v[56:59], a[88:91], v[140:143], v[56:59]
    buffer_load_dwordx4 v203, s[16:19], s45 offen offset:3072 nt lds
    s_waitcnt lgkmcnt(8)
    v_mfma_f32_16x16x32_bf16 v[44:47], a[92:95], v[136:139], v[44:47]
    ds_read_b64_tr_b16 a[112:113], v212 offset:45056
    ds_read_b64_tr_b16 a[114:115], v212 offset:47104
    v_mfma_f32_16x16x32_bf16 v[60:63], a[92:95], v[140:143], v[60:63]
    s_waitcnt lgkmcnt(8)
    v_mfma_f32_16x16x32_bf16 v[32:35], a[96:99], v[144:147], v[32:35]
    ds_read_b64_tr_b16 a[116:117], v213 offset:45056
    ds_read_b64_tr_b16 a[118:119], v213 offset:47104
    v_mfma_f32_16x16x32_bf16 v[48:51], a[96:99], v[148:151], v[48:51]
    s_waitcnt lgkmcnt(8)
    v_mfma_f32_16x16x32_bf16 v[36:39], a[100:103], v[144:147], v[36:39]
    ds_read_b64_tr_b16 a[120:121], v214 offset:45056
    ds_read_b64_tr_b16 a[122:123], v214 offset:47104
    v_mfma_f32_16x16x32_bf16 v[52:55], a[100:103], v[148:151], v[52:55]
    s_waitcnt lgkmcnt(8)
    v_mfma_f32_16x16x32_bf16 v[40:43], a[104:107], v[144:147], v[40:43]
    ds_read_b64_tr_b16 a[124:125], v215 offset:45056
    ds_read_b64_tr_b16 a[126:127], v215 offset:47104
    v_mfma_f32_16x16x32_bf16 v[56:59], a[104:107], v[148:151], v[56:59]
    s_waitcnt lgkmcnt(8)
    v_mfma_f32_16x16x32_bf16 v[44:47], a[108:111], v[144:147], v[44:47]
    s_waitcnt vmcnt(9)
    s_waitcnt vmcnt(4)
    s_barrier
    v_mov_b32 v232, 4
    s_or_b32 s53, s7, s6
    s_cbranch_scc0 L42
    buffer_store_dword v232, v235, s[36:39], 0 offen
L43:
    ds_read_b64_tr_b16 a[64:65], v216 offset:0
    ds_read_b64_tr_b16 a[66:67], v216 offset:2048
    v_mfma_f32_16x16x32_bf16 v[60:63], a[108:111], v[148:151], v[60:63]
    s_waitcnt lgkmcnt(8)
    v_mfma_f32_16x16x32_bf16 v[32:35], a[112:115], v[152:155], v[32:35]
    ds_read_b64_tr_b16 a[68:69], v217 offset:0
    ds_read_b64_tr_b16 a[70:71], v217 offset:2048
    v_mfma_f32_16x16x32_bf16 v[48:51], a[112:115], v[156:159], v[48:51]
    s_add_u32 m0, s41, 16384
    s_xor_b32 s45, s52, 65920
    buffer_load_dwordx4 v200, s[16:19], s45 offen offset:0 nt lds
    s_waitcnt lgkmcnt(8)
    v_mfma_f32_16x16x32_bf16 v[36:39], a[116:119], v[152:155], v[36:39]
    ds_read_b64_tr_b16 a[72:73], v218 offset:0
    ds_read_b64_tr_b16 a[74:75], v218 offset:2048
    v_mfma_f32_16x16x32_bf16 v[52:55], a[116:119], v[156:159], v[52:55]
    s_waitcnt lgkmcnt(8)
    v_mfma_f32_16x16x32_bf16 v[40:43], a[120:123], v[152:155], v[40:43]
    ds_read_b64_tr_b16 a[76:77], v219 offset:0
    ds_read_b64_tr_b16 a[78:79], v219 offset:2048
    v_mfma_f32_16x16x32_bf16 v[56:59], a[120:123], v[156:159], v[56:59]
    buffer_load_dwordx4 v201, s[16:19], s45 offen offset:1024 nt lds
    s_waitcnt lgkmcnt(8)
    v_mfma_f32_16x16x32_bf16 v[44:47], a[124:127], v[152:155], v[44:47]
    ds_read_b64_tr_b16 a[80:81], v216 offset:4096
    ds_read_b64_tr_b16 a[82:83], v216 offset:6144
    v_mfma_f32_16x16x32_bf16 v[60:63], a[124:127], v[156:159], v[60:63]
    s_waitcnt lgkmcnt(8)
    v_mfma_f32_16x16x32_bf16 v[32:35], a[64:67], v[160:163], v[32:35]
    ds_read_b64_tr_b16 a[84:85], v217 offset:4096
    ds_read_b64_tr_b16 a[86:87], v217 offset:6144
    v_mfma_f32_16x16x32_bf16 v[48:51], a[64:67], v[164:167], v[48:51]
    s_waitcnt lgkmcnt(8)
    v_mfma_f32_16x16x32_bf16 v[36:39], a[68:71], v[160:163], v[36:39]
    ds_read_b64_tr_b16 a[88:89], v218 offset:4096
    ds_read_b64_tr_b16 a[90:91], v218 offset:6144
    v_mfma_f32_16x16x32_bf16 v[52:55], a[68:71], v[164:167], v[52:55]
    s_waitcnt lgkmcnt(8)
    v_mfma_f32_16x16x32_bf16 v[40:43], a[72:75], v[160:163], v[40:43]
    ds_read_b64_tr_b16 a[92:93], v219 offset:4096
    ds_read_b64_tr_b16 a[94:95], v219 offset:6144
    v_mfma_f32_16x16x32_bf16 v[56:59], a[72:75], v[164:167], v[56:59]
    s_waitcnt lgkmcnt(8)
    v_mfma_f32_16x16x32_bf16 v[44:47], a[76:79], v[160:163], v[44:47]
    ds_read_b64_tr_b16 a[96:97], v216 offset:8192
    ds_read_b64_tr_b16 a[98:99], v216 offset:10240
    v_mfma_f32_16x16x32_bf16 v[60:63], a[76:79], v[164:167], v[60:63]
    s_waitcnt lgkmcnt(8)
    v_mfma_f32_16x16x32_bf16 v[32:35], a[80:83], v[168:171], v[32:35]
    ds_read_b64_tr_b16 a[100:101], v217 offset:8192
    ds_read_b64_tr_b16 a[102:103], v217 offset:10240
    v_mfma_f32_16x16x32_bf16 v[48:51], a[80:83], v[172:175], v[48:51]
    buffer_load_dword v237, v236, s[36:39], 0 offen sc1
    s_waitcnt lgkmcnt(8)
    v_mfma_f32_16x16x32_bf16 v[36:39], a[84:87], v[168:171], v[36:39]
    ds_read_b64_tr_b16 a[104:105], v218 offset:8192
    ds_read_b64_tr_b16 a[106:107], v218 offset:10240
    v_mfma_f32_16x16x32_bf16 v[52:55], a[84:87], v[172:175], v[52:55]
    buffer_load_dwordx4 v202, s[16:19], s45 offen offset:2048 nt lds
    s_waitcnt lgkmcnt(8)
    v_mfma_f32_16x16x32_bf16 v[40:43], a[88:91], v[168:171], v[40:43]
    ds_read_b64_tr_b16 a[108:109], v219 offset:8192
    ds_read_b64_tr_b16 a[110:111], v219 offset:10240
    v_mfma_f32_16x16x32_bf16 v[56:59], a[88:91], v[172:175], v[56:59]
    s_waitcnt lgkmcnt(8)
    v_mfma_f32_16x16x32_bf16 v[44:47], a[92:95], v[168:171], v[44:47]
    ds_read_b64_tr_b16 a[112:113], v216 offset:12288
    ds_read_b64_tr_b16 a[114:115], v216 offset:14336
    v_mfma_f32_16x16x32_bf16 v[60:63], a[92:95], v[172:175], v[60:63]
    buffer_load_dwordx4 v203, s[16:19], s45 offen offset:3072 nt lds
    s_waitcnt lgkmcnt(8)
    v_mfma_f32_16x16x32_bf16 v[32:35], a[96:99], v[176:179], v[32:35]
    ds_read_b64_tr_b16 a[116:117], v217 offset:12288
    ds_read_b64_tr_b16 a[118:119], v217 offset:14336
    v_mfma_f32_16x16x32_bf16 v[48:51], a[96:99], v[180:183], v[48:51]
    s_waitcnt lgkmcnt(8)
    v_mfma_f32_16x16x32_bf16 v[36:39], a[100:103], v[176:179], v[36:39]
    ds_read_b64_tr_b16 a[120:121], v218 offset:12288
    ds_read_b64_tr_b16 a[122:123], v218 offset:14336
    v_mfma_f32_16x16x32_bf16 v[52:55], a[100:103], v[180:183], v[52:55]
    s_waitcnt lgkmcnt(8)
    v_mfma_f32_16x16x32_bf16 v[40:43], a[104:107], v[176:179], v[40:43]
    ds_read_b64_tr_b16 a[124:125], v219 offset:12288
    ds_read_b64_tr_b16 a[126:127], v219 offset:14336
    v_mfma_f32_16x16x32_bf16 v[56:59], a[104:107], v[180:183], v[56:59]
    s_waitcnt lgkmcnt(8)
    v_mfma_f32_16x16x32_bf16 v[44:47], a[108:111], v[176:179], v[44:47]
    s_waitcnt vmcnt(6)
    s_barrier
    ds_read_b64_tr_b16 a[64:65], v208 offset:0
    ds_read_b64_tr_b16 a[66:67], v208 offset:2048
    v_mfma_f32_16x16x32_bf16 v[60:63], a[108:111], v[180:183], v[60:63]
    s_waitcnt lgkmcnt(8)
    v_mfma_f32_16x16x32_bf16 v[32:35], a[112:115], v[184:187], v[32:35]
    ds_read_b64_tr_b16 a[68:69], v209 offset:0
    ds_read_b64_tr_b16 a[70:71], v209 offset:2048
    v_mfma_f32_16x16x32_bf16 v[48:51], a[112:115], v[188:191], v[48:51]
    s_add_u32 m0, s41, 32768
    s_xor_b32 s45, s52, 0
    buffer_load_dwordx4 v200, s[16:19], s45 offen offset:0 nt lds
    s_waitcnt lgkmcnt(8)
    v_mfma_f32_16x16x32_bf16 v[36:39], a[116:119], v[184:187], v[36:39]
    ds_read_b64_tr_b16 a[72:73], v210 offset:0
    ds_read_b64_tr_b16 a[74:75], v210 offset:2048
    v_mfma_f32_16x16x32_bf16 v[52:55], a[116:119], v[188:191], v[52:55]
    s_waitcnt lgkmcnt(8)
    v_mfma_f32_16x16x32_bf16 v[40:43], a[120:123], v[184:187], v[40:43]
    ds_read_b64_tr_b16 a[76:77], v211 offset:0
    ds_read_b64_tr_b16 a[78:79], v211 offset:2048
    v_mfma_f32_16x16x32_bf16 v[56:59], a[120:123], v[188:191], v[56:59]
    buffer_load_dwordx4 v201, s[16:19], s45 offen offset:1024 nt lds
    s_waitcnt lgkmcnt(8)
    v_mfma_f32_16x16x32_bf16 v[44:47], a[124:127], v[184:187], v[44:47]
    ds_read_b64_tr_b16 a[80:81], v208 offset:4096
    ds_read_b64_tr_b16 a[82:83], v208 offset:6144
    v_mfma_f32_16x16x32_bf16 v[60:63], a[124:127], v[188:191], v[60:63]
    s_waitcnt lgkmcnt(8)
    v_mfma_f32_16x16x32_bf16 v[0:3], a[64:67], v[128:131], 0
    ds_read_b64_tr_b16 a[84:85], v209 offset:4096
    ds_read_b64_tr_b16 a[86:87], v209 offset:6144
    v_mfma_f32_16x16x32_bf16 v[16:19], a[64:67], v[132:135], 0
    buffer_load_dwordx4 v202, s[16:19], s45 offen offset:2048 nt lds
    s_waitcnt lgkmcnt(8)
    v_mfma_f32_16x16x32_bf16 v[4:7], a[68:71], v[128:131], 0
    ds_read_b64_tr_b16 a[88:89], v210 offset:4096
    ds_read_b64_tr_b16 a[90:91], v210 offset:6144
    v_mfma_f32_16x16x32_bf16 v[20:23], a[68:71], v[132:135], 0
    s_waitcnt lgkmcnt(8)
    v_mfma_f32_16x16x32_bf16 v[8:11], a[72:75], v[128:131], 0
    ds_read_b64_tr_b16 a[92:93], v211 offset:4096
    ds_read_b64_tr_b16 a[94:95], v211 offset:6144
    buffer_load_dwordx4 v203, s[16:19], s45 offen offset:3072 nt lds
    v_mfma_f32_16x16x32_bf16 v[24:27], a[72:75], v[132:135], 0
    v_cvt_pk_bf16_f32 v64, v32, v33
    v_cvt_pk_bf16_f32 v65, v34, v35
    s_waitcnt lgkmcnt(8)
    v_mfma_f32_16x16x32_bf16 v[12:15], a[76:79], v[128:131], 0
    ds_read_b64_tr_b16 a[96:97], v208 offset:8192
    ds_read_b64_tr_b16 a[98:99], v208 offset:10240
    v_mfma_f32_16x16x32_bf16 v[28:31], a[76:79], v[132:135], 0
    v_cvt_pk_bf16_f32 v66, v36, v37
    s_waitcnt lgkmcnt(8)
    v_mfma_f32_16x16x32_bf16 v[0:3], a[80:83], v[136:139], v[0:3]
    ds_read_b64_tr_b16 a[100:101], v209 offset:8192
    ds_read_b64_tr_b16 a[102:103], v209 offset:10240
    v_mfma_f32_16x16x32_bf16 v[16:19], a[80:83], v[140:143], v[16:19]
    v_cvt_pk_bf16_f32 v67, v38, v39
    s_waitcnt lgkmcnt(8)
    v_mfma_f32_16x16x32_bf16 v[4:7], a[84:87], v[136:139], v[4:7]
    ds_read_b64_tr_b16 a[104:105], v210 offset:8192
    ds_read_b64_tr_b16 a[106:107], v210 offset:10240
    v_cvt_pk_bf16_f32 v68, v40, v41
    v_mfma_f32_16x16x32_bf16 v[20:23], a[84:87], v[140:143], v[20:23]
    v_cvt_pk_bf16_f32 v69, v42, v43
    s_waitcnt lgkmcnt(8)
    v_mfma_f32_16x16x32_bf16 v[8:11], a[88:91], v[136:139], v[8:11]
    ds_read_b64_tr_b16 a[108:109], v211 offset:8192
    ds_read_b64_tr_b16 a[110:111], v211 offset:10240
    v_mfma_f32_16x16x32_bf16 v[24:27], a[88:91], v[140:143], v[24:27]
    v_cvt_pk_bf16_f32 v70, v44, v45
    s_waitcnt lgkmcnt(8)
    v_mfma_f32_16x16x32_bf16 v[12:15], a[92:95], v[136:139], v[12:15]
    ds_read_b64_tr_b16 a[112:113], v208 offset:12288
    ds_read_b64_tr_b16 a[114:115], v208 offset:14336
    v_mfma_f32_16x16x32_bf16 v[28:31], a[92:95], v[140:143], v[28:31]
    v_cvt_pk_bf16_f32 v71, v46, v47
    s_waitcnt lgkmcnt(8)
    v_mfma_f32_16x16x32_bf16 v[0:3], a[96:99], v[144:147], v[0:3]
    ds_read_b64_tr_b16 a[116:117], v209 offset:12288
    ds_read_b64_tr_b16 a[118:119], v209 offset:14336
    v_cvt_pk_bf16_f32 v72, v48, v49
    v_mfma_f32_16x16x32_bf16 v[16:19], a[96:99], v[148:151], v[16:19]
    v_cvt_pk_bf16_f32 v73, v50, v51
    s_waitcnt lgkmcnt(8)
    v_mfma_f32_16x16x32_bf16 v[4:7], a[100:103], v[144:147], v[4:7]
    ds_read_b64_tr_b16 a[120:121], v210 offset:12288
    ds_read_b64_tr_b16 a[122:123], v210 offset:14336
    v_mfma_f32_16x16x32_bf16 v[20:23], a[100:103], v[148:151], v[20:23]
    v_cvt_pk_bf16_f32 v74, v52, v53
    s_waitcnt lgkmcnt(8)
    v_mfma_f32_16x16x32_bf16 v[8:11], a[104:107], v[144:147], v[8:11]
    ds_read_b64_tr_b16 a[124:125], v211 offset:12288
    ds_read_b64_tr_b16 a[126:127], v211 offset:14336
    v_mfma_f32_16x16x32_bf16 v[24:27], a[104:107], v[148:151], v[24:27]
    v_cvt_pk_bf16_f32 v75, v54, v55
    s_waitcnt lgkmcnt(8)
    v_mfma_f32_16x16x32_bf16 v[12:15], a[108:111], v[144:147], v[12:15]
    v_cvt_pk_bf16_f32 v76, v56, v57
    v_mfma_f32_16x16x32_bf16 v[28:31], a[108:111], v[148:151], v[28:31]
    v_cvt_pk_bf16_f32 v77, v58, v59
    s_waitcnt lgkmcnt(6)
    v_mfma_f32_16x16x32_bf16 v[0:3], a[112:115], v[152:155], v[0:3]
    v_mfma_f32_16x16x32_bf16 v[16:19], a[112:115], v[156:159], v[16:19]
    v_cvt_pk_bf16_f32 v78, v60, v61
    s_waitcnt lgkmcnt(4)
    v_mfma_f32_16x16x32_bf16 v[4:7], a[116:119], v[152:155], v[4:7]
    v_mfma_f32_16x16x32_bf16 v[20:23], a[116:119], v[156:159], v[20:23]
    v_cvt_pk_bf16_f32 v79, v62, v63
    s_waitcnt lgkmcnt(2)
    v_mfma_f32_16x16x32_bf16 v[8:11], a[120:123], v[152:155], v[8:11]
    v_mfma_f32_16x16x32_bf16 v[24:27], a[120:123], v[156:159], v[24:27]
    s_waitcnt lgkmcnt(0)
    v_mfma_f32_16x16x32_bf16 v[12:15], a[124:127], v[152:155], v[12:15]
    v_mfma_f32_16x16x32_bf16 v[28:31], a[124:127], v[156:159], v[28:31]
    s_waitcnt vmcnt(6)
    v_cmp_gt_u32 vcc, 4, v237
    s_mov_b32 s51, 0
    s_cbranch_vccz L47
L44:
    buffer_load_dword v237, v236, s[36:39], 0 offen sc1
    s_add_u32 s51, s51, 1
    s_cmp_gt_u32 s51, 262144
    s_waitcnt vmcnt(0)
    v_cmp_gt_u32 vcc, 4, v237
    s_cbranch_scc1 L45
    s_cbranch_vccnz L44
L45:
L47:
    s_cmp_lg_u32 s7, 0
    s_cbranch_scc0 L48
L49:
    buffer_load_dwordx4 v[96:99], v234, s[36:39], s57 offen offset:0 sc1
    buffer_load_dwordx4 v[100:103], v234, s[36:39], s57 offen offset:1024 sc1
    buffer_load_dwordx4 v[104:107], v234, s[36:39], s57 offen offset:2048 sc1
    buffer_load_dwordx4 v[108:111], v234, s[36:39], s57 offen offset:3072 sc1
    s_waitcnt vmcnt(8)
    s_barrier
    ds_read_b64_tr_b16 a[64:65], v208 offset:16384
    ds_read_b64_tr_b16 a[66:67], v208 offset:18432
    ds_read_b64_tr_b16 a[68:69], v209 offset:16384
    ds_read_b64_tr_b16 a[70:71], v209 offset:18432
    ds_read_b64_tr_b16 a[72:73], v210 offset:16384
    ds_read_b64_tr_b16 a[74:75], v210 offset:18432
    ds_read_b64_tr_b16 a[76:77], v211 offset:16384
    ds_read_b64_tr_b16 a[78:79], v211 offset:18432
    ds_read_b64_tr_b16 a[80:81], v208 offset:20480
    ds_read_b64_tr_b16 a[82:83], v208 offset:22528
    s_waitcnt lgkmcnt(8)
    v_mfma_f32_16x16x32_bf16 v[0:3], a[64:67], v[160:163], v[0:3]
    ds_read_b64_tr_b16 a[84:85], v209 offset:20480
    ds_read_b64_tr_b16 a[86:87], v209 offset:22528
    v_mfma_f32_16x16x32_bf16 v[16:19], a[64:67], v[164:167], v[16:19]
    s_add_u32 m0, s41, 49152
    s_xor_b32 s45, s52, 65536
    buffer_load_dwordx4 v200, s[16:19], s45 offen offset:0 nt lds
    s_waitcnt lgkmcnt(8)
    v_mfma_f32_16x16x32_bf16 v[4:7], a[68:71], v[160:163], v[4:7]
    ds_read_b64_tr_b16 a[88:89], v210 offset:20480
    ds_read_b64_tr_b16 a[90:91], v210 offset:22528
    v_mfma_f32_16x16x32_bf16 v[20:23], a[68:71], v[164:167], v[20:23]
    s_waitcnt lgkmcnt(8)
    v_mfma_f32_16x16x32_bf16 v[8:11], a[72:75], v[160:163], v[8:11]
    ds_read_b64_tr_b16 a[92:93], v211 offset:20480
    ds_read_b64_tr_b16 a[94:95], v211 offset:22528
    v_mfma_f32_16x16x32_bf16 v[24:27], a[72:75], v[164:167], v[24:27]
    buffer_load_dwordx4 v201, s[16:19], s45 offen offset:1024 nt lds
    s_waitcnt lgkmcnt(8)
    v_mfma_f32_16x16x32_bf16 v[12:15], a[76:79], v[160:163], v[12:15]
    ds_read_b64_tr_b16 a[96:97], v208 offset:24576
    ds_read_b64_tr_b16 a[98:99], v208 offset:26624
    v_mfma_f32_16x16x32_bf16 v[28:31], a[76:79], v[164:167], v[28:31]
    s_waitcnt lgkmcnt(8)
    v_mfma_f32_16x16x32_bf16 v[0:3], a[80:83], v[168:171], v[0:3]
    ds_read_b64_tr_b16 a[100:101], v209 offset:24576
    ds_read_b64_tr_b16 a[102:103], v209 offset:26624
    v_mfma_f32_16x16x32_bf16 v[16:19], a[80:83], v[172:175], v[16:19]
    buffer_load_dwordx4 v202, s[16:19], s45 offen offset:2048 nt lds
    s_waitcnt lgkmcnt(8)
    v_mfma_f32_16x16x32_bf16 v[4:7], a[84:87], v[168:171], v[4:7]
    ds_read_b64_tr_b16 a[104:105], v210 offset:24576
    ds_read_b64_tr_b16 a[106:107], v210 offset:26624
    v_mfma_f32_16x16x32_bf16 v[20:23], a[84:87], v[172:175], v[20:23]
    s_waitcnt lgkmcnt(8)
    v_mfma_f32_16x16x32_bf16 v[8:11], a[88:91], v[168:171], v[8:11]
    ds_read_b64_tr_b16 a[108:109], v211 offset:24576
    ds_read_b64_tr_b16 a[110:111], v211 offset:26624
    v_mfma_f32_16x16x32_bf16 v[24:27], a[88:91], v[172:175], v[24:27]
    buffer_load_dwordx4 v203, s[16:19], s45 offen offset:3072 nt lds
    s_waitcnt lgkmcnt(8)
    v_mfma_f32_16x16x32_bf16 v[12:15], a[92:95], v[168:171], v[12:15]
    ds_read_b64_tr_b16 a[112:113], v208 offset:28672
    ds_read_b64_tr_b16 a[114:115], v208 offset:30720
    v_mfma_f32_16x16x32_bf16 v[28:31], a[92:95], v[172:175], v[28:31]
    s_waitcnt lgkmcnt(8)
    v_mfma_f32_16x16x32_bf16 v[0:3], a[96:99], v[176:179], v[0:3]
    ds_read_b64_tr_b16 a[116:117], v209 offset:28672
    ds_read_b64_tr_b16 a[118:119], v209 offset:30720
    v_mfma_f32_16x16x32_bf16 v[16:19], a[96:99], v[180:183], v[16:19]
    s_waitcnt lgkmcnt(8)
    v_mfma_f32_16x16x32_bf16 v[4:7], a[100:103], v[176:179], v[4:7]
    ds_read_b64_tr_b16 a[120:121], v210 offset:28672
    ds_read_b64_tr_b16 a[122:123], v210 offset:30720
    v_mfma_f32_16x16x32_bf16 v[20:23], a[100:103], v[180:183], v[20:23]
    s_waitcnt lgkmcnt(8)
    v_mfma_f32_16x16x32_bf16 v[8:11], a[104:107], v[176:179], v[8:11]
    ds_read_b64_tr_b16 a[124:125], v211 offset:28672
    ds_read_b64_tr_b16 a[126:127], v211 offset:30720
    v_mfma_f32_16x16x32_bf16 v[24:27], a[104:107], v[180:183], v[24:27]
    s_waitcnt lgkmcnt(8)
    v_mfma_f32_16x16x32_bf16 v[12:15], a[108:111], v[176:179], v[12:15]
    v_mfma_f32_16x16x32_bf16 v[28:31], a[108:111], v[180:183], v[28:31]
    s_waitcnt lgkmcnt(6)
    v_mfma_f32_16x16x32_bf16 v[0:3], a[112:115], v[184:187], v[0:3]
    v_mfma_f32_16x16x32_bf16 v[16:19], a[112:115], v[188:191], v[16:19]
    s_waitcnt lgkmcnt(4)
    v_mfma_f32_16x16x32_bf16 v[4:7], a[116:119], v[184:187], v[4:7]
    v_mfma_f32_16x16x32_bf16 v[20:23], a[116:119], v[188:191], v[20:23]
    s_waitcnt lgkmcnt(2)
    v_mfma_f32_16x16x32_bf16 v[8:11], a[120:123], v[184:187], v[8:11]
    v_mfma_f32_16x16x32_bf16 v[24:27], a[120:123], v[188:191], v[24:27]
    s_waitcnt lgkmcnt(0)
    v_mfma_f32_16x16x32_bf16 v[12:15], a[124:127], v[184:187], v[12:15]
    v_mfma_f32_16x16x32_bf16 v[28:31], a[124:127], v[188:191], v[28:31]
    s_waitcnt vmcnt(4)
    buffer_store_dwordx4 v[64:67], v234, s[36:39], s57 offen offset:0
    buffer_store_dwordx4 v[68:71], v234, s[36:39], s57 offen offset:1024
    buffer_store_dwordx4 v[72:75], v234, s[36:39], s57 offen offset:2048
    buffer_store_dwordx4 v[76:79], v234, s[36:39], s57 offen offset:3072
    v_cvt_pk_bf16_f32 v80, v0, v1
    v_cvt_pk_bf16_f32 v81, v2, v3
    v_cvt_pk_bf16_f32 v82, v4, v5
    v_cvt_pk_bf16_f32 v83, v6, v7
    v_cvt_pk_bf16_f32 v84, v8, v9
    v_cvt_pk_bf16_f32 v85, v10, v11
    v_cvt_pk_bf16_f32 v86, v12, v13
    v_cvt_pk_bf16_f32 v87, v14, v15
    v_cvt_pk_bf16_f32 v88, v16, v17
    v_cvt_pk_bf16_f32 v89, v18, v19
    v_cvt_pk_bf16_f32 v90, v20, v21
    v_cvt_pk_bf16_f32 v91, v22, v23
    v_cvt_pk_bf16_f32 v92, v24, v25
    v_cvt_pk_bf16_f32 v93, v26, v27
    v_cvt_pk_bf16_f32 v94, v28, v29
    v_cvt_pk_bf16_f32 v95, v30, v31
    v_and_b32 v200, 3, v226
    v_cmp_eq_u32 vcc, 2, v200
    s_nop 1
    v_cndmask_b32 v200, 0, 5, vcc
    s_barrier
    ds_read_b64_tr_b16 a[64:65], v208 offset:32768
    ds_read_b64_tr_b16 a[66:67], v208 offset:34816
    ds_read_b64_tr_b16 a[68:69], v209 offset:32768
    ds_read_b64_tr_b16 a[70:71], v209 offset:34816
    ds_read_b64_tr_b16 a[72:73], v210 offset:32768
    ds_read_b64_tr_b16 a[74:75], v210 offset:34816
    ds_read_b64_tr_b16 a[76:77], v211 offset:32768
    ds_read_b64_tr_b16 a[78:79], v211 offset:34816
    ds_read_b64_tr_b16 a[80:81], v208 offset:36864
    ds_read_b64_tr_b16 a[82:83], v208 offset:38912
    s_waitcnt lgkmcnt(8)
    v_mfma_f32_16x16x32_bf16 v[32:35], a[64:67], v[128:131], 0
    ds_read_b64_tr_b16 a[84:85], v209 offset:36864
    ds_read_b64_tr_b16 a[86:87], v209 offset:38912
    v_mfma_f32_16x16x32_bf16 v[48:51], a[64:67], v[132:135], 0
    buffer_load_dwordx4 v[238:241], v253, s[36:39], s57 offen sc1
    s_waitcnt lgkmcnt(8)
    v_mfma_f32_16x16x32_bf16 v[36:39], a[68:71], v[128:131], 0
    ds_read_b64_tr_b16 a[88:89], v210 offset:36864
    ds_read_b64_tr_b16 a[90:91], v210 offset:38912
    v_mfma_f32_16x16x32_bf16 v[52:55], a[68:71], v[132:135], 0
    buffer_load_dwordx4 v[242:245], v253, s[36:39], s58 offen sc1
    s_waitcnt lgkmcnt(8)
    v_mfma_f32_16x16x32_bf16 v[40:43], a[72:75], v[128:131], 0
    ds_read_b64_tr_b16 a[92:93], v211 offset:36864
    ds_read_b64_tr_b16 a[94:95], v211 offset:38912
    v_mfma_f32_16x16x32_bf16 v[56:59], a[72:75], v[132:135], 0
    s_waitcnt lgkmcnt(8)
    v_mfma_f32_16x16x32_bf16 v[44:47], a[76:79], v[128:131], 0
    ds_read_b64_tr_b16 a[96:97], v208 offset:40960
    ds_read_b64_tr_b16 a[98:99], v208 offset:43008
    v_mfma_f32_16x16x32_bf16 v[60:63], a[76:79], v[132:135], 0
    buffer_load_dwordx4 v[246:249], v253, s[36:39], s59 offen sc1
    s_waitcnt lgkmcnt(8)
    v_mfma_f32_16x16x32_bf16 v[32:35], a[80:83], v[136:139], v[32:35]
    ds_read_b64_tr_b16 a[100:101], v209 offset:40960
    ds_read_b64_tr_b16 a[102:103], v209 offset:43008
    v_mfma_f32_16x16x32_bf16 v[48:51], a[80:83], v[140:143], v[48:51]
    s_add_u32 m0, s41, 131072
    s_xor_b32 s49, s5, 2
    s_mul_i32 s49, s49, 57344
    s_add_u32 s49, s49, s47
    buffer_load_dwordx4 v204, s[24:27], s49 offen offset:0  lds
    s_waitcnt lgkmcnt(8)
    v_mfma_f32_16x16x32_bf16 v[36:39], a[84:87], v[136:139], v[36:39]
    ds_read_b64_tr_b16 a[104:105], v210 offset:40960
    ds_read_b64_tr_b16 a[106:107], v210 offset:43008
    v_mfma_f32_16x16x32_bf16 v[52:55], a[84:87], v[140:143], v[52:55]
    s_waitcnt lgkmcnt(8)
    v_mfma_f32_16x16x32_bf16 v[40:43], a[88:91], v[136:139], v[40:43]
    ds_read_b64_tr_b16 a[108:109], v211 offset:40960
    ds_read_b64_tr_b16 a[110:111], v211 offset:43008
    v_mfma_f32_16x16x32_bf16 v[56:59], a[88:91], v[140:143], v[56:59]
    buffer_load_dwordx4 v205, s[24:27], s49 offen offset:1024  lds
    s_waitcnt lgkmcnt(8)
    v_mfma_f32_16x16x32_bf16 v[44:47], a[92:95], v[136:139], v[44:47]
    ds_read_b64_tr_b16 a[112:113], v208 offset:45056
    ds_read_b64_tr_b16 a[114:115], v208 offset:47104
    v_mfma_f32_16x16x32_bf16 v[60:63], a[92:95], v[140:143], v[60:63]
    buffer_load_dwordx4 v206, s[24:27], s49 offen offset:2048  lds
    s_waitcnt lgkmcnt(8)
    v_mfma_f32_16x16x32_bf16 v[32:35], a[96:99], v[144:147], v[32:35]
    ds_read_b64_tr_b16 a[116:117], v209 offset:45056
    ds_read_b64_tr_b16 a[118:119], v209 offset:47104
    v_mfma_f32_16x16x32_bf16 v[48:51], a[96:99], v[148:151], v[48:51]
    s_waitcnt lgkmcnt(8)
    v_mfma_f32_16x16x32_bf16 v[36:39], a[100:103], v[144:147], v[36:39]
    ds_read_b64_tr_b16 a[120:121], v210 offset:45056
    ds_read_b64_tr_b16 a[122:123], v210 offset:47104
    v_mfma_f32_16x16x32_bf16 v[52:55], a[100:103], v[148:151], v[52:55]
    buffer_load_dwordx4 v207, s[24:27], s49 offen offset:3072  lds
    s_waitcnt lgkmcnt(8)
    v_mfma_f32_16x16x32_bf16 v[40:43], a[104:107], v[144:147], v[40:43]
    ds_read_b64_tr_b16 a[124:125], v211 offset:45056
    ds_read_b64_tr_b16 a[126:127], v211 offset:47104
    v_mfma_f32_16x16x32_bf16 v[56:59], a[104:107], v[148:151], v[56:59]
    s_waitcnt lgkmcnt(8)
    v_mfma_f32_16x16x32_bf16 v[44:47], a[108:111], v[144:147], v[44:47]
    s_waitcnt vmcnt(11)
    s_barrier
    ds_read_b64_tr_b16 a[64:65], v208 offset:49152
    ds_read_b64_tr_b16 a[66:67], v208 offset:51200
    v_mfma_f32_16x16x32_bf16 v[60:63], a[108:111], v[148:151], v[60:63]
    s_waitcnt vmcnt(7)
    s_barrier
    v_mov_b32 v232, 5
    s_or_b32 s53, s7, s6
    s_cbranch_scc0 L50
    buffer_store_dword v232, v235, s[36:39], 0 offen
L51:
    s_waitcnt lgkmcnt(8)
    v_mfma_f32_16x16x32_bf16 v[32:35], a[112:115], v[152:155], v[32:35]
    ds_read_b64_tr_b16 a[68:69], v209 offset:49152
    ds_read_b64_tr_b16 a[70:71], v209 offset:51200
    v_mfma_f32_16x16x32_bf16 v[48:51], a[112:115], v[156:159], v[48:51]
    s_add_u32 m0, s41, 147456
    s_xor_b32 s49, s5, 6
    s_mul_i32 s49, s49, 57344
    s_add_u32 s49, s49, s47
    buffer_load_dwordx4 v204, s[24:27], s49 offen offset:0  lds
    s_waitcnt lgkmcnt(8)
    v_mfma_f32_16x16x32_bf16 v[36:39], a[116:119], v[152:155], v[36:39]
    ds_read_b64_tr_b16 a[72:73], v210 offset:49152
    ds_read_b64_tr_b16 a[74:75], v210 offset:51200
    v_mfma_f32_16x16x32_bf16 v[52:55], a[116:119], v[156:159], v[52:55]
    s_waitcnt lgkmcnt(8)
    v_mfma_f32_16x16x32_bf16 v[40:43], a[120:123], v[152:155], v[40:43]
    ds_read_b64_tr_b16 a[76:77], v211 offset:49152
    ds_read_b64_tr_b16 a[78:79], v211 offset:51200
    v_mfma_f32_16x16x32_bf16 v[56:59], a[120:123], v[156:159], v[56:59]
    buffer_load_dwordx4 v205, s[24:27], s49 offen offset:1024  lds
    s_waitcnt lgkmcnt(8)
    v_mfma_f32_16x16x32_bf16 v[44:47], a[124:127], v[152:155], v[44:47]
    ds_read_b64_tr_b16 a[80:81], v208 offset:53248
    ds_read_b64_tr_b16 a[82:83], v208 offset:55296
    v_mfma_f32_16x16x32_bf16 v[60:63], a[124:127], v[156:159], v[60:63]
    s_waitcnt lgkmcnt(8)
    v_mfma_f32_16x16x32_bf16 v[32:35], a[64:67], v[160:163], v[32:35]
    ds_read_b64_tr_b16 a[84:85], v209 offset:53248
    ds_read_b64_tr_b16 a[86:87], v209 offset:55296
    v_mfma_f32_16x16x32_bf16 v[48:51], a[64:67], v[164:167], v[48:51]
    buffer_load_dwordx4 v206, s[24:27], s49 offen offset:2048  lds
    s_waitcnt lgkmcnt(8)
    v_mfma_f32_16x16x32_bf16 v[36:39], a[68:71], v[160:163], v[36:39]
    ds_read_b64_tr_b16 a[88:89], v210 offset:53248
    ds_read_b64_tr_b16 a[90:91], v210 offset:55296
    v_mfma_f32_16x16x32_bf16 v[52:55], a[68:71], v[164:167], v[52:55]
    s_waitcnt lgkmcnt(8)
    v_mfma_f32_16x16x32_bf16 v[40:43], a[72:75], v[160:163], v[40:43]
    ds_read_b64_tr_b16 a[92:93], v211 offset:53248
    ds_read_b64_tr_b16 a[94:95], v211 offset:55296
    v_mfma_f32_16x16x32_bf16 v[56:59], a[72:75], v[164:167], v[56:59]
    buffer_load_dword v237, v236, s[36:39], 0 offen sc1
    s_waitcnt lgkmcnt(8)
    v_mfma_f32_16x16x32_bf16 v[44:47], a[76:79], v[160:163], v[44:47]
    ds_read_b64_tr_b16 a[96:97], v208 offset:57344
    ds_read_b64_tr_b16 a[98:99], v208 offset:59392
    v_mfma_f32_16x16x32_bf16 v[60:63], a[76:79], v[164:167], v[60:63]
    s_waitcnt lgkmcnt(8)
    v_mfma_f32_16x16x32_bf16 v[32:35], a[80:83], v[168:171], v[32:35]
    ds_read_b64_tr_b16 a[100:101], v209 offset:57344
    ds_read_b64_tr_b16 a[102:103], v209 offset:59392
    v_mfma_f32_16x16x32_bf16 v[48:51], a[80:83], v[172:175], v[48:51]
    s_waitcnt lgkmcnt(8)
    v_mfma_f32_16x16x32_bf16 v[36:39], a[84:87], v[168:171], v[36:39]
    ds_read_b64_tr_b16 a[104:105], v210 offset:57344
    ds_read_b64_tr_b16 a[106:107], v210 offset:59392
    v_mfma_f32_16x16x32_bf16 v[52:55], a[84:87], v[172:175], v[52:55]
    s_waitcnt lgkmcnt(8)
    v_mfma_f32_16x16x32_bf16 v[40:43], a[88:91], v[168:171], v[40:43]
    ds_read_b64_tr_b16 a[108:109], v211 offset:57344
    ds_read_b64_tr_b16 a[110:111], v211 offset:59392
    v_mfma_f32_16x16x32_bf16 v[56:59], a[88:91], v[172:175], v[56:59]
    s_waitcnt lgkmcnt(8)
    v_mfma_f32_16x16x32_bf16 v[44:47], a[92:95], v[168:171], v[44:47]
    ds_read_b64_tr_b16 a[112:113], v208 offset:61440
    ds_read_b64_tr_b16 a[114:115], v208 offset:63488
    v_mfma_f32_16x16x32_bf16 v[60:63], a[92:95], v[172:175], v[60:63]
    s_waitcnt lgkmcnt(8)
    v_mfma_f32_16x16x32_bf16 v[32:35], a[96:99], v[176:179], v[32:35]
    ds_read_b64_tr_b16 a[116:117], v209 offset:61440
    ds_read_b64_tr_b16 a[118:119], v209 offset:63488
    v_mfma_f32_16x16x32_bf16 v[48:51], a[96:99], v[180:183], v[48:51]
    s_waitcnt lgkmcnt(8)
    v_mfma_f32_16x16x32_bf16 v[36:39], a[100:103], v[176:179], v[36:39]
    ds_read_b64_tr_b16 a[120:121], v210 offset:61440
    ds_read_b64_tr_b16 a[122:123], v210 offset:63488
    s_waitcnt vmcnt(0)
    v_cmp_gt_u32 vcc, v200, v237
    s_mov_b32 s51, 0
    s_cbranch_vccz L55
L52:
    buffer_load_dword v237, v236, s[36:39], 0 offen sc1
    s_add_u32 s51, s51, 1
    s_cmp_gt_u32 s51, 262144
    s_waitcnt vmcnt(0)
    v_cmp_gt_u32 vcc, v200, v237
    s_cbranch_scc1 L53
    s_cbranch_vccnz L52
L53:
L55:
    s_cmp_lg_u32 s7, 0
    s_cbranch_scc0 L56
L57:
    v_mfma_f32_16x16x32_bf16 v[52:55], a[100:103], v[180:183], v[52:55]
    buffer_load_dwordx4 v[112:115], v234, s[36:39], s59 offen offset:0 sc1
    s_waitcnt lgkmcnt(8)
    v_mfma_f32_16x16x32_bf16 v[40:43], a[104:107], v[176:179], v[40:43]
    ds_read_b64_tr_b16 a[124:125], v211 offset:61440
    ds_read_b64_tr_b16 a[126:127], v211 offset:63488
    v_mfma_f32_16x16x32_bf16 v[56:59], a[104:107], v[180:183], v[56:59]
    buffer_load_dwordx4 v[116:119], v234, s[36:39], s59 offen offset:1024 sc1
    s_waitcnt lgkmcnt(8)
    v_mfma_f32_16x16x32_bf16 v[44:47], a[108:111], v[176:179], v[44:47]
    v_mfma_f32_16x16x32_bf16 v[60:63], a[108:111], v[180:183], v[60:63]
    buffer_load_dwordx4 v[120:123], v234, s[36:39], s59 offen offset:2048 sc1
    s_waitcnt lgkmcnt(6)
    v_mfma_f32_16x16x32_bf16 v[32:35], a[112:115], v[184:187], v[32:35]
    v_mfma_f32_16x16x32_bf16 v[48:51], a[112:115], v[188:191], v[48:51]
    buffer_load_dwordx4 v[124:127], v234, s[36:39], s59 offen offset:3072 sc1
    s_waitcnt lgkmcnt(4)
    v_mfma_f32_16x16x32_bf16 v[36:39], a[116:119], v[184:187], v[36:39]
    v_mfma_f32_16x16x32_bf16 v[52:55], a[116:119], v[188:191], v[52:55]
    v_and_b32 v200, 3, v226
    s_waitcnt lgkmcnt(2)
    v_mfma_f32_16x16x32_bf16 v[40:43], a[120:123], v[184:187], v[40:43]
    v_mfma_f32_16x16x32_bf16 v[56:59], a[120:123], v[188:191], v[56:59]
    v_cmp_eq_u32 vcc, 3, v200
    s_waitcnt lgkmcnt(0)
    v_mfma_f32_16x16x32_bf16 v[44:47], a[124:127], v[184:187], v[44:47]
    v_mfma_f32_16x16x32_bf16 v[60:63], a[124:127], v[188:191], v[60:63]
    v_cndmask_b32 v200, 0, 6, vcc
    v_max3_f32 v254, v228, v238, v242
    v_max3_f32 v255, v229, v239, v243
    v_max_f32 v254, v254, v246
    v_max_f32 v255, v255, v247
    v_sub_f32 v192, v228, v254
    v_sub_f32 v193, v229, v255
    v_sub_f32 v194, v238, v254
    v_sub_f32 v195, v239, v255
    v_sub_f32 v196, v242, v254
    v_sub_f32 v197, v243, v255
    v_sub_f32 v198, v246, v254
    v_sub_f32 v199, v247, v255
    v_exp_f32 v192, v192
    v_exp_f32 v193, v193
    v_exp_f32 v194, v194
    v_exp_f32 v195, v195
    v_exp_f32 v196, v196
    v_exp_f32 v197, v197
    v_exp_f32 v198, v198
    v_exp_f32 v199, v199
    v_mul_f32 v254, v192, v230
    v_mul_f32 v255, v193, v231
    v_fmac_f32 v254, v194, v240
    v_fmac_f32 v255, v195, v241
    v_fmac_f32 v254, v196, v244
    v_fmac_f32 v255, v197, v245
    v_fmac_f32 v254, v198, v248
    v_fmac_f32 v255, v199, v249
    v_rcp_f32 v254, v254
    v_rcp_f32 v255, v255
    v_mul_f32 v192, v192, v254
    v_mul_f32 v193, v193, v255
    v_mul_f32 v194, v194, v254
    v_mul_f32 v195, v195, v255
    v_mul_f32 v196, v196, v254
    v_mul_f32 v197, v197, v255
    v_mul_f32 v198, v198, v254
    v_mul_f32 v199, v199, v255
    s_waitcnt vmcnt(0)
    buffer_store_dwordx4 v[80:83], v234, s[36:39], s59 offen offset:0
    buffer_store_dwordx4 v[84:87], v234, s[36:39], s59 offen offset:1024
    buffer_store_dwordx4 v[88:91], v234, s[36:39], s59 offen offset:2048
    buffer_store_dwordx4 v[92:95], v234, s[36:39], s59 offen offset:3072
    v_lshlrev_b32 v254, 16, v96
    buffer_load_dwordx4 v207, s[24:27], s49 offen offset:3072  lds
    v_and_b32 v255, 0xffff0000, v96
    v_pk_mul_f32 v[0:1], v[254:255], v[194:195] op_sel:[0,0] op_sel_hi:[1,0]
    v_lshlrev_b32 v250, 16, v97
    v_and_b32 v251, 0xffff0000, v97
    v_pk_mul_f32 v[2:3], v[250:251], v[194:195] op_sel:[0,0] op_sel_hi:[1,0]
    v_lshlrev_b32 v254, 16, v98
    v_and_b32 v255, 0xffff0000, v98
    v_pk_mul_f32 v[4:5], v[254:255], v[194:195] op_sel:[0,0] op_sel_hi:[1,0]
    v_lshlrev_b32 v250, 16, v99
    s_add_u32 m0, s41, 65536
    s_xor_b32 s49, s5, 3
    s_mul_i32 s49, s49, 57344
    s_add_u32 s49, s49, s47
    buffer_load_dwordx4 v204, s[24:27], s49 offen offset:0  lds
    v_and_b32 v251, 0xffff0000, v99
    v_pk_mul_f32 v[6:7], v[250:251], v[194:195] op_sel:[0,0] op_sel_hi:[1,0]
    v_lshlrev_b32 v254, 16, v100
    v_and_b32 v255, 0xffff0000, v100
    v_pk_mul_f32 v[8:9], v[254:255], v[194:195] op_sel:[0,0] op_sel_hi:[1,0]
    v_lshlrev_b32 v250, 16, v101
    v_and_b32 v251, 0xffff0000, v101
    v_pk_mul_f32 v[10:11], v[250:251], v[194:195] op_sel:[0,0] op_sel_hi:[1,0]
    v_lshlrev_b32 v254, 16, v102
    v_and_b32 v255, 0xffff0000, v102
    buffer_load_dwordx4 v205, s[24:27], s49 offen offset:1024  lds
    v_pk_mul_f32 v[12:13], v[254:255], v[194:195] op_sel:[0,0] op_sel_hi:[1,0]
    v_lshlrev_b32 v250, 16, v103
    v_and_b32 v251, 0xffff0000, v103
    v_pk_mul_f32 v[14:15], v[250:251], v[194:195] op_sel:[0,0] op_sel_hi:[1,0]
    v_lshlrev_b32 v254, 16, v104
    v_and_b32 v255, 0xffff0000, v104
    v_pk_mul_f32 v[16:17], v[254:255], v[194:195] op_sel:[0,1] op_sel_hi:[1,1]
    v_lshlrev_b32 v250, 16, v105
    v_and_b32 v251, 0xffff0000, v105
    buffer_load_dwordx4 v206, s[24:27], s49 offen offset:2048  lds
    v_pk_mul_f32 v[18:19], v[250:251], v[194:195] op_sel:[0,1] op_sel_hi:[1,1]
    v_lshlrev_b32 v254, 16, v106
    v_and_b32 v255, 0xffff0000, v106
    v_pk_mul_f32 v[20:21], v[254:255], v[194:195] op_sel:[0,1] op_sel_hi:[1,1]
    v_lshlrev_b32 v250, 16, v107
    v_and_b32 v251, 0xffff0000, v107
    v_pk_mul_f32 v[22:23], v[250:251], v[194:195] op_sel:[0,1] op_sel_hi:[1,1]
    v_lshlrev_b32 v254, 16, v108
    v_and_b32 v255, 0xffff0000, v108
    v_pk_mul_f32 v[24:25], v[254:255], v[194:195] op_sel:[0,1] op_sel_hi:[1,1]
    buffer_load_dwordx4 v207, s[24:27], s49 offen offset:3072  lds
    v_lshlrev_b32 v250, 16, v109
    v_and_b32 v251, 0xffff0000, v109
    v_pk_mul_f32 v[26:27], v[250:251], v[194:195] op_sel:[0,1] op_sel_hi:[1,1]
    v_lshlrev_b32 v254, 16, v110
    v_and_b32 v255, 0xffff0000, v110
    v_pk_mul_f32 v[28:29], v[254:255], v[194:195] op_sel:[0,1] op_sel_hi:[1,1]
    v_lshlrev_b32 v250, 16, v111
    v_and_b32 v251, 0xffff0000, v111
    v_pk_mul_f32 v[30:31], v[250:251], v[194:195] op_sel:[0,1] op_sel_hi:[1,1]
    s_waitcnt vmcnt(5)
    s_barrier
    v_mov_b32 v232, 6
    s_or_b32 s53, s7, s6
    s_cbranch_scc0 L58
    buffer_store_dword v232, v235, s[36:39], 0 offen
L59:
    v_lshlrev_b32 v254, 16, v112
    v_and_b32 v255, 0xffff0000, v112
    v_pk_fma_f32 v[0:1], v[254:255], v[196:197], v[0:1] op_sel:[0,0,0] op_sel_hi:[1,0,1]
    v_lshlrev_b32 v250, 16, v113
    v_and_b32 v251, 0xffff0000, v113
    v_pk_fma_f32 v[2:3], v[250:251], v[196:197], v[2:3] op_sel:[0,0,0] op_sel_hi:[1,0,1]
    v_lshlrev_b32 v254, 16, v114
    v_and_b32 v255, 0xffff0000, v114
    v_pk_fma_f32 v[4:5], v[254:255], v[196:197], v[4:5] op_sel:[0,0,0] op_sel_hi:[1,0,1]
    v_lshlrev_b32 v250, 16, v115
    v_and_b32 v251, 0xffff0000, v115
    v_pk_fma_f32 v[6:7], v[250:251], v[196:197], v[6:7] op_sel:[0,0,0] op_sel_hi:[1,0,1]
    v_lshlrev_b32 v254, 16, v116
    v_and_b32 v255, 0xffff0000, v116
    v_pk_fma_f32 v[8:9], v[254:255], v[196:197], v[8:9] op_sel:[0,0,0] op_sel_hi:[1,0,1]
    v_lshlrev_b32 v250, 16, v117
    v_and_b32 v251, 0xffff0000, v117
    v_pk_fma_f32 v[10:11], v[250:251], v[196:197], v[10:11] op_sel:[0,0,0] op_sel_hi:[1,0,1]
    v_lshlrev_b32 v254, 16, v118
    v_and_b32 v255, 0xffff0000, v118
    v_pk_fma_f32 v[12:13], v[254:255], v[196:197], v[12:13] op_sel:[0,0,0] op_sel_hi:[1,0,1]
    v_lshlrev_b32 v250, 16, v119
    v_and_b32 v251, 0xffff0000, v119
    v_pk_fma_f32 v[14:15], v[250:251], v[196:197], v[14:15] op_sel:[0,0,0] op_sel_hi:[1,0,1]
    buffer_load_dword v237, v236, s[36:39], 0 offen sc1
    v_lshlrev_b32 v254, 16, v120
    v_and_b32 v255, 0xffff0000, v120
    v_pk_fma_f32 v[16:17], v[254:255], v[196:197], v[16:17] op_sel:[0,1,0] op_sel_hi:[1,1,1]
    v_lshlrev_b32 v250, 16, v121
    v_and_b32 v251, 0xffff0000, v121
    v_pk_fma_f32 v[18:19], v[250:251], v[196:197], v[18:19] op_sel:[0,1,0] op_sel_hi:[1,1,1]
    v_lshlrev_b32 v254, 16, v122
    v_and_b32 v255, 0xffff0000, v122
    v_pk_fma_f32 v[20:21], v[254:255], v[196:197], v[20:21] op_sel:[0,1,0] op_sel_hi:[1,1,1]
    v_lshlrev_b32 v250, 16, v123
    v_and_b32 v251, 0xffff0000, v123
    v_pk_fma_f32 v[22:23], v[250:251], v[196:197], v[22:23] op_sel:[0,1,0] op_sel_hi:[1,1,1]
    v_lshlrev_b32 v254, 16, v124
    v_and_b32 v255, 0xffff0000, v124
    v_pk_fma_f32 v[24:25], v[254:255], v[196:197], v[24:25] op_sel:[0,1,0] op_sel_hi:[1,1,1]
    v_lshlrev_b32 v250, 16, v125
    v_and_b32 v251, 0xffff0000, v125
    v_pk_fma_f32 v[26:27], v[250:251], v[196:197], v[26:27] op_sel:[0,1,0] op_sel_hi:[1,1,1]
    v_lshlrev_b32 v254, 16, v126
    v_and_b32 v255, 0xffff0000, v126
    v_pk_fma_f32 v[28:29], v[254:255], v[196:197], v[28:29] op_sel:[0,1,0] op_sel_hi:[1,1,1]
    v_lshlrev_b32 v250, 16, v127
    v_and_b32 v251, 0xffff0000, v127
    v_pk_fma_f32 v[30:31], v[250:251], v[196:197], v[30:31] op_sel:[0,1,0] op_sel_hi:[1,1,1]
    s_waitcnt vmcnt(0)
    v_cmp_gt_u32 vcc, v200, v237
    s_mov_b32 s51, 0
    s_cbranch_vccz L63
L60:
    buffer_load_dword v237, v236, s[36:39], 0 offen sc1
    s_add_u32 s51, s51, 1
    s_cmp_gt_u32 s51, 262144
    s_waitcnt vmcnt(0)
    v_cmp_gt_u32 vcc, v200, v237
    s_cbranch_scc1 L61
    s_cbranch_vccnz L60
L61:
L63:
    s_cmp_lg_u32 s7, 0
    s_cbranch_scc0 L64
L65:
    buffer_load_dwordx4 v[96:99], v234, s[36:39], s56 offen offset:0 sc1
    buffer_load_dwordx4 v[100:103], v234, s[36:39], s56 offen offset:1024 sc1
    buffer_load_dwordx4 v[104:107], v234, s[36:39], s56 offen offset:2048 sc1
    buffer_load_dwordx4 v[108:111], v234, s[36:39], s56 offen offset:3072 sc1
    v_pk_fma_f32 v[0:1], v[32:33], v[192:193], v[0:1] op_sel:[0,0,0] op_sel_hi:[1,0,1]
    v_pk_fma_f32 v[2:3], v[34:35], v[192:193], v[2:3] op_sel:[0,0,0] op_sel_hi:[1,0,1]
    v_pk_fma_f32 v[4:5], v[36:37], v[192:193], v[4:5] op_sel:[0,0,0] op_sel_hi:[1,0,1]
    v_pk_fma_f32 v[6:7], v[38:39], v[192:193], v[6:7] op_sel:[0,0,0] op_sel_hi:[1,0,1]
    v_pk_fma_f32 v[8:9], v[40:41], v[192:193], v[8:9] op_sel:[0,0,0] op_sel_hi:[1,0,1]
    v_pk_fma_f32 v[10:11], v[42:43], v[192:193], v[10:11] op_sel:[0,0,0] op_sel_hi:[1,0,1]
    v_pk_fma_f32 v[12:13], v[44:45], v[192:193], v[12:13] op_sel:[0,0,0] op_sel_hi:[1,0,1]
    v_pk_fma_f32 v[14:15], v[46:47], v[192:193], v[14:15] op_sel:[0,0,0] op_sel_hi:[1,0,1]
    v_pk_fma_f32 v[16:17], v[48:49], v[192:193], v[16:17] op_sel:[0,1,0] op_sel_hi:[1,1,1]
    v_pk_fma_f32 v[18:19], v[50:51], v[192:193], v[18:19] op_sel:[0,1,0] op_sel_hi:[1,1,1]
    v_pk_fma_f32 v[20:21], v[52:53], v[192:193], v[20:21] op_sel:[0,1,0] op_sel_hi:[1,1,1]
    v_pk_fma_f32 v[22:23], v[54:55], v[192:193], v[22:23] op_sel:[0,1,0] op_sel_hi:[1,1,1]
    v_pk_fma_f32 v[24:25], v[56:57], v[192:193], v[24:25] op_sel:[0,1,0] op_sel_hi:[1,1,1]
    v_pk_fma_f32 v[26:27], v[58:59], v[192:193], v[26:27] op_sel:[0,1,0] op_sel_hi:[1,1,1]
    v_pk_fma_f32 v[28:29], v[60:61], v[192:193], v[28:29] op_sel:[0,1,0] op_sel_hi:[1,1,1]
    v_pk_fma_f32 v[30:31], v[62:63], v[192:193], v[30:31] op_sel:[0,1,0] op_sel_hi:[1,1,1]
    s_waitcnt vmcnt(3)
    v_lshlrev_b32 v254, 16, v96
    v_and_b32 v255, 0xffff0000, v96
    v_pk_fma_f32 v[0:1], v[254:255], v[198:199], v[0:1] op_sel:[0,0,0] op_sel_hi:[1,0,1]
    v_lshlrev_b32 v250, 16, v97
    v_and_b32 v251, 0xffff0000, v97
    v_pk_fma_f32 v[2:3], v[250:251], v[198:199], v[2:3] op_sel:[0,0,0] op_sel_hi:[1,0,1]
    v_lshlrev_b32 v254, 16, v98
    v_and_b32 v255, 0xffff0000, v98
    v_pk_fma_f32 v[4:5], v[254:255], v[198:199], v[4:5] op_sel:[0,0,0] op_sel_hi:[1,0,1]
    v_lshlrev_b32 v250, 16, v99
    v_and_b32 v251, 0xffff0000, v99
    v_pk_fma_f32 v[6:7], v[250:251], v[198:199], v[6:7] op_sel:[0,0,0] op_sel_hi:[1,0,1]
    v_cvt_pk_bf16_f32 v64, v0, v1
    v_cvt_pk_bf16_f32 v65, v2, v3
    v_cvt_pk_bf16_f32 v66, v4, v5
    v_cvt_pk_bf16_f32 v67, v6, v7
    buffer_store_dwordx4 v[64:67], v234, s[36:39], s56 offen offset:0
    ds_write_b128 v234, v[64:67] offset:0
    s_waitcnt vmcnt(3)
    v_lshlrev_b32 v254, 16, v100
    v_and_b32 v255, 0xffff0000, v100
    v_pk_fma_f32 v[8:9], v[254:255], v[198:199], v[8:9] op_sel:[0,0,0] op_sel_hi:[1,0,1]
    v_lshlrev_b32 v250, 16, v101
    v_and_b32 v251, 0xffff0000, v101
    v_pk_fma_f32 v[10:11], v[250:251], v[198:199], v[10:11] op_sel:[0,0,0] op_sel_hi:[1,0,1]
    v_lshlrev_b32 v254, 16, v102
    v_and_b32 v255, 0xffff0000, v102
    v_pk_fma_f32 v[12:13], v[254:255], v[198:199], v[12:13] op_sel:[0,0,0] op_sel_hi:[1,0,1]
    v_lshlrev_b32 v250, 16, v103
    v_and_b32 v251, 0xffff0000, v103
    v_pk_fma_f32 v[14:15], v[250:251], v[198:199], v[14:15] op_sel:[0,0,0] op_sel_hi:[1,0,1]
    v_cvt_pk_bf16_f32 v68, v8, v9
    v_cvt_pk_bf16_f32 v69, v10, v11
    v_cvt_pk_bf16_f32 v70, v12, v13
    v_cvt_pk_bf16_f32 v71, v14, v15
    buffer_store_dwordx4 v[68:71], v234, s[36:39], s56 offen offset:1024
    ds_write_b128 v234, v[68:71] offset:1024
    s_waitcnt vmcnt(3)
    v_lshlrev_b32 v254, 16, v104
    v_and_b32 v255, 0xffff0000, v104
    v_pk_fma_f32 v[16:17], v[254:255], v[198:199], v[16:17] op_sel:[0,1,0] op_sel_hi:[1,1,1]
    v_lshlrev_b32 v250, 16, v105
    v_and_b32 v251, 0xffff0000, v105
    v_pk_fma_f32 v[18:19], v[250:251], v[198:199], v[18:19] op_sel:[0,1,0] op_sel_hi:[1,1,1]
    v_lshlrev_b32 v254, 16, v106
    v_and_b32 v255, 0xffff0000, v106
    v_pk_fma_f32 v[20:21], v[254:255], v[198:199], v[20:21] op_sel:[0,1,0] op_sel_hi:[1,1,1]
    v_lshlrev_b32 v250, 16, v107
    v_and_b32 v251, 0xffff0000, v107
    v_pk_fma_f32 v[22:23], v[250:251], v[198:199], v[22:23] op_sel:[0,1,0] op_sel_hi:[1,1,1]
    v_cvt_pk_bf16_f32 v72, v16, v17
    v_cvt_pk_bf16_f32 v73, v18, v19
    v_cvt_pk_bf16_f32 v74, v20, v21
    v_cvt_pk_bf16_f32 v75, v22, v23
    buffer_store_dwordx4 v[72:75], v234, s[36:39], s56 offen offset:2048
    ds_write_b128 v234, v[72:75] offset:2048
    s_waitcnt vmcnt(3)
    v_lshlrev_b32 v254, 16, v108
    v_and_b32 v255, 0xffff0000, v108
    v_pk_fma_f32 v[24:25], v[254:255], v[198:199], v[24:25] op_sel:[0,1,0] op_sel_hi:[1,1,1]
    v_lshlrev_b32 v250, 16, v109
    v_and_b32 v251, 0xffff0000, v109
    v_pk_fma_f32 v[26:27], v[250:251], v[198:199], v[26:27] op_sel:[0,1,0] op_sel_hi:[1,1,1]
    v_lshlrev_b32 v254, 16, v110
    v_and_b32 v255, 0xffff0000, v110
    v_pk_fma_f32 v[28:29], v[254:255], v[198:199], v[28:29] op_sel:[0,1,0] op_sel_hi:[1,1,1]
    v_lshlrev_b32 v250, 16, v111
    v_and_b32 v251, 0xffff0000, v111
    v_pk_fma_f32 v[30:31], v[250:251], v[198:199], v[30:31] op_sel:[0,1,0] op_sel_hi:[1,1,1]
    v_cvt_pk_bf16_f32 v76, v24, v25
    v_cvt_pk_bf16_f32 v77, v26, v27
    v_cvt_pk_bf16_f32 v78, v28, v29
    v_cvt_pk_bf16_f32 v79, v30, v31
    buffer_store_dwordx4 v[76:79], v234, s[36:39], s56 offen offset:3072
    ds_write_b128 v234, v[76:79] offset:3072
    s_add_u32 m0, s41, 81920
    s_xor_b32 s49, s5, 7
    s_mul_i32 s49, s49, 57344
    s_add_u32 s49, s49, s47
    buffer_load_dwordx4 v204, s[24:27], s49 offen offset:0  lds
    buffer_load_dwordx4 v205, s[24:27], s49 offen offset:1024  lds
    buffer_load_dwordx4 v206, s[24:27], s49 offen offset:2048  lds
    buffer_load_dwordx4 v207, s[24:27], s49 offen offset:3072  lds
    s_lshr_b32 s43, s2, 3
    s_lshl_b32 s43, s43, 7
    s_add_u32 s43, s43, 33558528
    s_lshl_b32 s44, s3, 13
    s_add_u32 s44, s44, s43
    v_and_b32 v52, 7, v226
    v_lshl_add_u32 v48, v52, 2, s44
    s_lshl2_add_u32 s43, s3, s43
    v_lshl_add_u32 v49, v52, 13, s43
    v_mov_b32 v54, 268435456
    v_cmp_ne_u32 vcc, s3, v52
    v_mov_b32 v50, 1
    s_nop 0
    v_cndmask_b32 v49, v54, v49, vcc
    v_cmp_gt_u32 vcc, 128, v234
    s_add_u32 s49, s56, 16777216
    s_nop 0
    v_cndmask_b32 v49, v54, v49, vcc
    v_and_b32 v52, 7, v226
    v_cmp_ne_u32 vcc, s3, v52
    s_nop 1
    v_cndmask_b32 v53, 0, 1, vcc
    s_lshl2_add_u32 s45, s5, s6
    s_cmp_ge_u32 s45, 14
    s_cselect_b32 s49, 268435456, s49
    s_lshr_b32 s43, s3, 2
    s_lshl2_add_u32 s45, s43, s6
    s_and_b32 s46, s3, 3
    s_and_b32 s43, s45, 6
    s_lshl1_add_u32 s43, s43, s46
    s_lshl_b32 s43, s43, 10
    s_and_b32 s44, s6, 1
    s_lshl3_add_u32 s43, s44, s43
    s_and_b32 s40, s56, 507904
    s_add_u32 s40, s40, s43
    s_add_u32 s40, s40, 16777216
    v_and_b32 v51, 15, v226
    v_mul_u32_u24 v51, 896, v51
    v_lshrrev_b32 v52, 4, v226
    v_lshl_add_u32 v51, v52, 3, v51
    s_lshl2_add_u32 s43, s4, s46
    s_mul_i32 s43, s43, 14336
    s_lshl3_add_u32 s45, s5, s45
    s_lshl_b32 s45, s45, 5
    s_add_u32 s48, s43, s45
    s_mul_i32 s43, s44, 504
    s_add_u32 s40, s40, s43
    s_lshl_b32 s43, s44, 4
    s_sub_u32 s48, s48, s43
    v_lshrrev_b32 v52, 5, v226
    v_lshl_add_u32 v51, v52, 4, v51
    v_and_b32 v55, 0x1ff, v227
    v_lshl_add_u32 v55, v52, 21, v55
    s_waitcnt vmcnt(4)
    s_waitcnt lgkmcnt(0)
    s_barrier
    v_mov_b32 v232, 7
    s_or_b32 s53, s7, s6
    s_cbranch_scc0 L66
    buffer_store_dword v232, v235, s[36:39], 0 offen
L67:
    ds_read_b128 a[64:67], v227 offset:0
    ds_read_b128 a[68:71], v227 offset:2048
    ds_read_b128 a[72:75], v227 offset:4096
    ds_read_b128 a[76:79], v227 offset:6144
    ds_read_b128 a[80:83], v227 offset:1024
    ds_read_b128 a[84:87], v227 offset:3072
    s_waitcnt lgkmcnt(5)
    v_mfma_f32_16x16x32_bf16 v[0:3], a[128:131], a[64:67], 0
    ds_read_b128 a[88:91], v227 offset:5120
    v_mfma_f32_16x16x32_bf16 v[4:7], a[132:135], a[64:67], 0
    s_waitcnt lgkmcnt(5)
    v_mfma_f32_16x16x32_bf16 v[8:11], a[128:131], a[68:71], 0
    ds_read_b128 a[92:95], v227 offset:7168
    v_mfma_f32_16x16x32_bf16 v[12:15], a[132:135], a[68:71], 0
    s_waitcnt lgkmcnt(5)
    v_mfma_f32_16x16x32_bf16 v[16:19], a[128:131], a[72:75], 0
    ds_read_b128 a[96:99], v227 offset:8192
    v_mfma_f32_16x16x32_bf16 v[20:23], a[132:135], a[72:75], 0
    s_waitcnt lgkmcnt(5)
    v_mfma_f32_16x16x32_bf16 v[24:27], a[128:131], a[76:79], 0
    ds_read_b128 a[100:103], v227 offset:10240
    v_mfma_f32_16x16x32_bf16 v[28:31], a[132:135], a[76:79], 0
    buffer_load_dword v237, v236, s[36:39], 0 offen sc1
    s_waitcnt lgkmcnt(5)
    v_mfma_f32_16x16x32_bf16 v[0:3], a[136:139], a[80:83], v[0:3]
    ds_read_b128 a[104:107], v227 offset:12288
    v_mfma_f32_16x16x32_bf16 v[4:7], a[140:143], a[80:83], v[4:7]
    s_waitcnt lgkmcnt(5)
    v_mfma_f32_16x16x32_bf16 v[8:11], a[136:139], a[84:87], v[8:11]
    ds_read_b128 a[108:111], v227 offset:14336
    v_mfma_f32_16x16x32_bf16 v[12:15], a[140:143], a[84:87], v[12:15]
    s_waitcnt lgkmcnt(5)
    v_mfma_f32_16x16x32_bf16 v[16:19], a[136:139], a[88:91], v[16:19]
    ds_read_b128 a[112:115], v227 offset:9216
    v_mfma_f32_16x16x32_bf16 v[20:23], a[140:143], a[88:91], v[20:23]
    s_waitcnt lgkmcnt(5)
    v_mfma_f32_16x16x32_bf16 v[24:27], a[136:139], a[92:95], v[24:27]
    ds_read_b128 a[116:119], v227 offset:11264
    v_mfma_f32_16x16x32_bf16 v[28:31], a[140:143], a[92:95], v[28:31]
    s_waitcnt lgkmcnt(5)
    v_mfma_f32_16x16x32_bf16 v[0:3], a[144:147], a[96:99], v[0:3]
    ds_read_b128 a[120:123], v227 offset:13312
    s_waitcnt vmcnt(0)
    v_cmp_gt_u32 vcc, 7, v237
    s_mov_b32 s51, 0
    s_cbranch_vccz L71
L68:
    buffer_load_dword v237, v236, s[36:39], 0 offen sc1
    s_add_u32 s51, s51, 1
    s_cmp_gt_u32 s51, 262144
    s_waitcnt vmcnt(0)
    v_cmp_gt_u32 vcc, 7, v237
    s_cbranch_scc1 L69
    s_cbranch_vccnz L68
L69:
L71:
    s_cmp_lg_u32 s7, 0
    s_cbranch_scc0 L72
L73:
    s_add_u32 m0, s41, 16384
    s_nop 0
    buffer_load_dwordx4 v234, s[36:39], s57 offen offset:0 sc1 lds
    v_mfma_f32_16x16x32_bf16 v[4:7], a[148:151], a[96:99], v[4:7]
    buffer_load_dwordx4 v234, s[36:39], s57 offen offset:1024 sc1 lds
    buffer_load_dwordx4 v234, s[36:39], s57 offen offset:2048 sc1 lds
    buffer_load_dwordx4 v234, s[36:39], s57 offen offset:3072 sc1 lds
    s_waitcnt lgkmcnt(5)
    v_mfma_f32_16x16x32_bf16 v[8:11], a[144:147], a[100:103], v[8:11]
    ds_read_b128 a[124:127], v227 offset:15360
    v_mfma_f32_16x16x32_bf16 v[12:15], a[148:151], a[100:103], v[12:15]
    s_add_u32 m0, s41, 32768
    s_nop 0
    buffer_load_dwordx4 v234, s[36:39], s58 offen offset:0 sc1 lds
    s_waitcnt lgkmcnt(5)
    v_mfma_f32_16x16x32_bf16 v[16:19], a[144:147], a[104:107], v[16:19]
    v_mfma_f32_16x16x32_bf16 v[20:23], a[148:151], a[104:107], v[20:23]
    buffer_load_dwordx4 v234, s[36:39], s58 offen offset:1024 sc1 lds
    s_waitcnt lgkmcnt(4)
    v_mfma_f32_16x16x32_bf16 v[24:27], a[144:147], a[108:111], v[24:27]
    v_mfma_f32_16x16x32_bf16 v[28:31], a[148:151], a[108:111], v[28:31]
    buffer_load_dwordx4 v234, s[36:39], s58 offen offset:2048 sc1 lds
    s_waitcnt lgkmcnt(3)
    v_mfma_f32_16x16x32_bf16 v[0:3], a[152:155], a[112:115], v[0:3]
    v_mfma_f32_16x16x32_bf16 v[4:7], a[156:159], a[112:115], v[4:7]
    buffer_load_dwordx4 v234, s[36:39], s58 offen offset:3072 sc1 lds
    s_waitcnt lgkmcnt(2)
    v_mfma_f32_16x16x32_bf16 v[8:11], a[152:155], a[116:119], v[8:11]
    v_mfma_f32_16x16x32_bf16 v[12:15], a[156:159], a[116:119], v[12:15]
    ds_read_b64_tr_b16 a[192:193], v224 offset:0
    ds_read_b64_tr_b16 a[194:195], v224 offset:4096
    ds_read_b64_tr_b16 a[196:197], v225 offset:0
    ds_read_b64_tr_b16 a[198:199], v225 offset:4096
    ds_read_b64_tr_b16 a[200:201], v224 offset:8192
    ds_read_b64_tr_b16 a[202:203], v224 offset:12288
    ds_read_b64_tr_b16 a[204:205], v225 offset:8192
    ds_read_b64_tr_b16 a[206:207], v225 offset:12288
    ds_read_b64_tr_b16 a[208:209], v224 offset:16384
    ds_read_b64_tr_b16 a[210:211], v224 offset:20480
    ds_read_b64_tr_b16 a[212:213], v225 offset:16384
    ds_read_b64_tr_b16 a[214:215], v225 offset:20480
    ds_read_b64_tr_b16 a[216:217], v224 offset:24576
    ds_read_b64_tr_b16 a[218:219], v224 offset:28672
    ds_read_b64_tr_b16 a[220:221], v225 offset:24576
    ds_read_b64_tr_b16 a[222:223], v225 offset:28672
    ds_read_b64_tr_b16 a[224:225], v222 offset:0
    ds_read_b64_tr_b16 a[226:227], v222 offset:4096
    ds_read_b64_tr_b16 a[228:229], v223 offset:0
    ds_read_b64_tr_b16 a[230:231], v223 offset:4096
    ds_read_b64_tr_b16 a[232:233], v222 offset:8192
    ds_read_b64_tr_b16 a[234:235], v222 offset:12288
    ds_read_b64_tr_b16 a[236:237], v223 offset:8192
    ds_read_b64_tr_b16 a[238:239], v223 offset:12288
    s_waitcnt lgkmcnt(15)
    v_mfma_f32_16x16x32_bf16 v[16:19], a[152:155], a[120:123], v[16:19]
    s_waitcnt vmcnt(4)
    s_barrier
    ds_read_b64_tr_b16 a[240:241], v222 offset:16384
    ds_read_b64_tr_b16 a[242:243], v222 offset:20480
    ds_read_b64_tr_b16 a[244:245], v223 offset:16384
    ds_read_b64_tr_b16 a[246:247], v223 offset:20480
    ds_read_b64_tr_b16 a[248:249], v222 offset:24576
    ds_read_b64_tr_b16 a[250:251], v222 offset:28672
    ds_read_b64_tr_b16 a[252:253], v223 offset:24576
    ds_read_b64_tr_b16 a[254:255], v223 offset:28672
    ds_read_b128 a[64:67], v227 offset:16384
    ds_read_b128 a[68:71], v227 offset:18432
    ds_read_b128 a[72:75], v227 offset:20480
    ds_read_b128 a[76:79], v227 offset:22528
    ds_read_b128 a[80:83], v227 offset:17408
    v_mfma_f32_16x16x32_bf16 v[20:23], a[156:159], a[120:123], v[20:23]
    v_mfma_f32_16x16x32_bf16 v[24:27], a[152:155], a[124:127], v[24:27]
    ds_read_b128 a[84:87], v227 offset:19456
    v_mfma_f32_16x16x32_bf16 v[28:31], a[156:159], a[124:127], v[28:31]
    s_waitcnt lgkmcnt(5)
    v_mfma_f32_16x16x32_bf16 v[0:3], a[160:163], a[64:67], v[0:3]
    ds_read_b128 a[88:91], v227 offset:21504
    v_mfma_f32_16x16x32_bf16 v[4:7], a[164:167], a[64:67], v[4:7]
    s_add_u32 m0, s41, 49152
    s_nop 0
    buffer_load_dwordx4 v234, s[36:39], s59 offen offset:0 sc1 lds
    s_waitcnt lgkmcnt(5)
    v_mfma_f32_16x16x32_bf16 v[8:11], a[160:163], a[68:71], v[8:11]
    ds_read_b128 a[92:95], v227 offset:23552
    v_mfma_f32_16x16x32_bf16 v[12:15], a[164:167], a[68:71], v[12:15]
    s_waitcnt lgkmcnt(5)
    v_mfma_f32_16x16x32_bf16 v[16:19], a[160:163], a[72:75], v[16:19]
    ds_read_b128 a[96:99], v227 offset:24576
    v_mfma_f32_16x16x32_bf16 v[20:23], a[164:167], a[72:75], v[20:23]
    buffer_load_dwordx4 v234, s[36:39], s59 offen offset:1024 sc1 lds
    s_waitcnt lgkmcnt(5)
    v_mfma_f32_16x16x32_bf16 v[24:27], a[160:163], a[76:79], v[24:27]
    ds_read_b128 a[100:103], v227 offset:26624
    v_mfma_f32_16x16x32_bf16 v[28:31], a[164:167], a[76:79], v[28:31]
    s_waitcnt lgkmcnt(5)
    v_mfma_f32_16x16x32_bf16 v[0:3], a[168:171], a[80:83], v[0:3]
    ds_read_b128 a[104:107], v227 offset:28672
    v_mfma_f32_16x16x32_bf16 v[4:7], a[172:175], a[80:83], v[4:7]
    buffer_load_dwordx4 v234, s[36:39], s59 offen offset:2048 sc1 lds
    s_waitcnt lgkmcnt(5)
    v_mfma_f32_16x16x32_bf16 v[8:11], a[168:171], a[84:87], v[8:11]
    ds_read_b128 a[108:111], v227 offset:30720
    v_mfma_f32_16x16x32_bf16 v[12:15], a[172:175], a[84:87], v[12:15]
    s_waitcnt lgkmcnt(5)
    v_mfma_f32_16x16x32_bf16 v[16:19], a[168:171], a[88:91], v[16:19]
    ds_read_b128 a[112:115], v227 offset:25600
    v_mfma_f32_16x16x32_bf16 v[20:23], a[172:175], a[88:91], v[20:23]
    buffer_load_dwordx4 v234, s[36:39], s59 offen offset:3072 sc1 lds
    s_waitcnt lgkmcnt(5)
    v_mfma_f32_16x16x32_bf16 v[24:27], a[168:171], a[92:95], v[24:27]
    ds_read_b128 a[116:119], v227 offset:27648
    v_mfma_f32_16x16x32_bf16 v[28:31], a[172:175], a[92:95], v[28:31]
    s_waitcnt lgkmcnt(5)
    v_mfma_f32_16x16x32_bf16 v[0:3], a[176:179], a[96:99], v[0:3]
    ds_read_b128 a[120:123], v227 offset:29696
    v_mfma_f32_16x16x32_bf16 v[4:7], a[180:183], a[96:99], v[4:7]
    s_waitcnt lgkmcnt(5)
    v_mfma_f32_16x16x32_bf16 v[8:11], a[176:179], a[100:103], v[8:11]
    ds_read_b128 a[124:127], v227 offset:31744
    v_mfma_f32_16x16x32_bf16 v[12:15], a[180:183], a[100:103], v[12:15]
    s_waitcnt lgkmcnt(5)
    v_mfma_f32_16x16x32_bf16 v[16:19], a[176:179], a[104:107], v[16:19]
    s_waitcnt vmcnt(4)
    s_barrier
    ds_read_b128 a[64:67], v227 offset:32768
    v_mfma_f32_16x16x32_bf16 v[20:23], a[180:183], a[104:107], v[20:23]
    s_waitcnt lgkmcnt(5)
    v_mfma_f32_16x16x32_bf16 v[24:27], a[176:179], a[108:111], v[24:27]
    ds_read_b128 a[68:71], v227 offset:34816
    v_mfma_f32_16x16x32_bf16 v[28:31], a[180:183], a[108:111], v[28:31]
    s_waitcnt lgkmcnt(5)
    v_mfma_f32_16x16x32_bf16 v[0:3], a[184:187], a[112:115], v[0:3]
    ds_read_b128 a[72:75], v227 offset:36864
    v_mfma_f32_16x16x32_bf16 v[4:7], a[188:191], a[112:115], v[4:7]
    s_waitcnt lgkmcnt(5)
    v_mfma_f32_16x16x32_bf16 v[8:11], a[184:187], a[116:119], v[8:11]
    ds_read_b128 a[76:79], v227 offset:38912
    v_mfma_f32_16x16x32_bf16 v[12:15], a[188:191], a[116:119], v[12:15]
    s_waitcnt lgkmcnt(5)
    v_mfma_f32_16x16x32_bf16 v[16:19], a[184:187], a[120:123], v[16:19]
    ds_read_b128 a[80:83], v227 offset:33792
    v_mfma_f32_16x16x32_bf16 v[20:23], a[188:191], a[120:123], v[20:23]
    s_waitcnt lgkmcnt(5)
    v_mfma_f32_16x16x32_bf16 v[24:27], a[184:187], a[124:127], v[24:27]
    ds_read_b128 a[84:87], v227 offset:35840
    v_mfma_f32_16x16x32_bf16 v[28:31], a[188:191], a[124:127], v[28:31]
    s_waitcnt lgkmcnt(5)
    v_mfma_f32_16x16x32_bf16 v[0:3], a[192:195], a[64:67], v[0:3]
    ds_read_b128 a[88:91], v227 offset:37888
    v_mfma_f32_16x16x32_bf16 v[4:7], a[196:199], a[64:67], v[4:7]
    s_waitcnt lgkmcnt(5)
    v_mfma_f32_16x16x32_bf16 v[8:11], a[192:195], a[68:71], v[8:11]
    ds_read_b128 a[92:95], v227 offset:39936
    v_mfma_f32_16x16x32_bf16 v[12:15], a[196:199], a[68:71], v[12:15]
    s_waitcnt lgkmcnt(5)
    v_mfma_f32_16x16x32_bf16 v[16:19], a[192:195], a[72:75], v[16:19]
    ds_read_b128 a[96:99], v227 offset:40960
    v_mfma_f32_16x16x32_bf16 v[20:23], a[196:199], a[72:75], v[20:23]
    s_waitcnt lgkmcnt(5)
    v_mfma_f32_16x16x32_bf16 v[24:27], a[192:195], a[76:79], v[24:27]
    ds_read_b128 a[100:103], v227 offset:43008
    v_mfma_f32_16x16x32_bf16 v[28:31], a[196:199], a[76:79], v[28:31]
    s_waitcnt lgkmcnt(5)
    v_mfma_f32_16x16x32_bf16 v[0:3], a[200:203], a[80:83], v[0:3]
    ds_read_b128 a[104:107], v227 offset:45056
    v_mfma_f32_16x16x32_bf16 v[4:7], a[204:207], a[80:83], v[4:7]
    s_waitcnt lgkmcnt(5)
    v_mfma_f32_16x16x32_bf16 v[8:11], a[200:203], a[84:87], v[8:11]
    ds_read_b128 a[108:111], v227 offset:47104
    v_mfma_f32_16x16x32_bf16 v[12:15], a[204:207], a[84:87], v[12:15]
    s_waitcnt lgkmcnt(5)
    v_mfma_f32_16x16x32_bf16 v[16:19], a[200:203], a[88:91], v[16:19]
    ds_read_b128 a[112:115], v227 offset:41984
    v_mfma_f32_16x16x32_bf16 v[20:23], a[204:207], a[88:91], v[20:23]
    s_waitcnt lgkmcnt(5)
    v_mfma_f32_16x16x32_bf16 v[24:27], a[200:203], a[92:95], v[24:27]
    ds_read_b128 a[116:119], v227 offset:44032
    v_mfma_f32_16x16x32_bf16 v[28:31], a[204:207], a[92:95], v[28:31]
    s_waitcnt lgkmcnt(5)
    v_mfma_f32_16x16x32_bf16 v[0:3], a[208:211], a[96:99], v[0:3]
    ds_read_b128 a[120:123], v227 offset:46080
    v_mfma_f32_16x16x32_bf16 v[4:7], a[212:215], a[96:99], v[4:7]
    s_waitcnt lgkmcnt(5)
    v_mfma_f32_16x16x32_bf16 v[8:11], a[208:211], a[100:103], v[8:11]
    ds_read_b128 a[124:127], v227 offset:48128
    v_mfma_f32_16x16x32_bf16 v[12:15], a[212:215], a[100:103], v[12:15]
    s_waitcnt lgkmcnt(5)
    v_mfma_f32_16x16x32_bf16 v[16:19], a[208:211], a[104:107], v[16:19]
    s_waitcnt vmcnt(0)
    s_barrier
    ds_read_b128 a[64:67], v227 offset:49152
    v_mfma_f32_16x16x32_bf16 v[20:23], a[212:215], a[104:107], v[20:23]
    s_waitcnt lgkmcnt(5)
    v_mfma_f32_16x16x32_bf16 v[24:27], a[208:211], a[108:111], v[24:27]
    ds_read_b128 a[68:71], v227 offset:50176
    v_mfma_f32_16x16x32_bf16 v[28:31], a[212:215], a[108:111], v[28:31]
    s_waitcnt lgkmcnt(5)
    v_mfma_f32_16x16x32_bf16 v[0:3], a[216:219], a[112:115], v[0:3]
    ds_read_b128 a[72:75], v227 offset:57344
    v_mfma_f32_16x16x32_bf16 v[4:7], a[220:223], a[112:115], v[4:7]
    s_waitcnt lgkmcnt(5)
    v_mfma_f32_16x16x32_bf16 v[8:11], a[216:219], a[116:119], v[8:11]
    ds_read_b128 a[76:79], v227 offset:58368
    v_mfma_f32_16x16x32_bf16 v[12:15], a[220:223], a[116:119], v[12:15]
    s_waitcnt lgkmcnt(5)
    v_mfma_f32_16x16x32_bf16 v[16:19], a[216:219], a[120:123], v[16:19]
    ds_read_b128 a[80:83], v227 offset:51200
    v_mfma_f32_16x16x32_bf16 v[20:23], a[220:223], a[120:123], v[20:23]
    s_waitcnt lgkmcnt(5)
    v_mfma_f32_16x16x32_bf16 v[24:27], a[216:219], a[124:127], v[24:27]
    ds_read_b128 a[84:87], v227 offset:52224
    v_mfma_f32_16x16x32_bf16 v[28:31], a[220:223], a[124:127], v[28:31]
    s_waitcnt lgkmcnt(5)
    v_mfma_f32_16x16x32_bf16 v[0:3], a[224:227], a[64:67], v[0:3]
    ds_read_b128 a[88:91], v227 offset:59392
    v_mfma_f32_16x16x32_bf16 v[4:7], a[228:231], a[64:67], v[4:7]
    s_waitcnt lgkmcnt(5)
    v_mfma_f32_16x16x32_bf16 v[0:3], a[232:235], a[68:71], v[0:3]
    ds_read_b128 a[92:95], v227 offset:60416
    v_mfma_f32_16x16x32_bf16 v[4:7], a[236:239], a[68:71], v[4:7]
    s_waitcnt lgkmcnt(5)
    v_mfma_f32_16x16x32_bf16 v[0:3], a[240:243], a[72:75], v[0:3]
    ds_read_b128 a[96:99], v227 offset:53248
    v_mfma_f32_16x16x32_bf16 v[4:7], a[244:247], a[72:75], v[4:7]
    s_waitcnt lgkmcnt(5)
    v_mfma_f32_16x16x32_bf16 v[0:3], a[248:251], a[76:79], v[0:3]
    ds_read_b128 a[100:103], v227 offset:54272
    v_mfma_f32_16x16x32_bf16 v[4:7], a[252:255], a[76:79], v[4:7]
    s_waitcnt lgkmcnt(5)
    v_mfma_f32_16x16x32_bf16 v[8:11], a[224:227], a[80:83], v[8:11]
    ds_read_b128 a[104:107], v227 offset:61440
    v_mfma_f32_16x16x32_bf16 v[12:15], a[228:231], a[80:83], v[12:15]
    s_waitcnt lgkmcnt(5)
    v_mfma_f32_16x16x32_bf16 v[8:11], a[232:235], a[84:87], v[8:11]
    ds_read_b128 a[108:111], v227 offset:62464
    v_cvt_pk_bf16_f32 v32, v0, v1
    v_mfma_f32_16x16x32_bf16 v[12:15], a[236:239], a[84:87], v[12:15]
    v_cvt_pk_bf16_f32 v33, v2, v3
    s_waitcnt lgkmcnt(5)
    v_mfma_f32_16x16x32_bf16 v[8:11], a[240:243], a[88:91], v[8:11]
    ds_read_b128 a[112:115], v227 offset:55296
    v_cvt_pk_bf16_f32 v34, v4, v5
    v_mfma_f32_16x16x32_bf16 v[12:15], a[244:247], a[88:91], v[12:15]
    v_cvt_pk_bf16_f32 v35, v6, v7
    s_waitcnt lgkmcnt(5)
    v_mfma_f32_16x16x32_bf16 v[8:11], a[248:251], a[92:95], v[8:11]
    ds_read_b128 a[116:119], v227 offset:56320
    v_mfma_f32_16x16x32_bf16 v[12:15], a[252:255], a[92:95], v[12:15]
    buffer_store_dwordx4 v[32:35], v234, s[36:39], s49 offen offset:0 sc1
    s_waitcnt lgkmcnt(5)
    v_mfma_f32_16x16x32_bf16 v[16:19], a[224:227], a[96:99], v[16:19]
    ds_read_b128 a[120:123], v227 offset:63488
    v_mfma_f32_16x16x32_bf16 v[20:23], a[228:231], a[96:99], v[20:23]
    s_waitcnt lgkmcnt(5)
    v_mfma_f32_16x16x32_bf16 v[16:19], a[232:235], a[100:103], v[16:19]
    ds_read_b128 a[124:127], v227 offset:64512
    v_cvt_pk_bf16_f32 v36, v8, v9
    v_mfma_f32_16x16x32_bf16 v[20:23], a[236:239], a[100:103], v[20:23]
    v_cvt_pk_bf16_f32 v37, v10, v11
    s_waitcnt lgkmcnt(5)
    v_mfma_f32_16x16x32_bf16 v[16:19], a[240:243], a[104:107], v[16:19]
    v_cvt_pk_bf16_f32 v38, v12, v13
    v_mfma_f32_16x16x32_bf16 v[20:23], a[244:247], a[104:107], v[20:23]
    v_cvt_pk_bf16_f32 v39, v14, v15
    s_waitcnt lgkmcnt(4)
    v_mfma_f32_16x16x32_bf16 v[16:19], a[248:251], a[108:111], v[16:19]
    v_mfma_f32_16x16x32_bf16 v[20:23], a[252:255], a[108:111], v[20:23]
    buffer_store_dwordx4 v[36:39], v234, s[36:39], s49 offen offset:1024 sc1
    s_waitcnt lgkmcnt(3)
    v_mfma_f32_16x16x32_bf16 v[24:27], a[224:227], a[112:115], v[24:27]
    v_mfma_f32_16x16x32_bf16 v[28:31], a[228:231], a[112:115], v[28:31]
    s_waitcnt lgkmcnt(2)
    v_mfma_f32_16x16x32_bf16 v[24:27], a[232:235], a[116:119], v[24:27]
    s_nop 0
    v_cvt_pk_bf16_f32 v40, v16, v17
    v_mfma_f32_16x16x32_bf16 v[28:31], a[236:239], a[116:119], v[28:31]
    v_cvt_pk_bf16_f32 v41, v18, v19
    s_waitcnt lgkmcnt(1)
    v_mfma_f32_16x16x32_bf16 v[24:27], a[240:243], a[120:123], v[24:27]
    v_cvt_pk_bf16_f32 v42, v20, v21
    v_mfma_f32_16x16x32_bf16 v[28:31], a[244:247], a[120:123], v[28:31]
    v_cvt_pk_bf16_f32 v43, v22, v23
    s_waitcnt lgkmcnt(0)
    v_mfma_f32_16x16x32_bf16 v[24:27], a[248:251], a[124:127], v[24:27]
    v_mfma_f32_16x16x32_bf16 v[28:31], a[252:255], a[124:127], v[28:31]
    buffer_store_dwordx4 v[40:43], v234, s[36:39], s49 offen offset:2048 sc1
    s_nop 5
    v_cvt_pk_bf16_f32 v44, v24, v25
    v_cvt_pk_bf16_f32 v45, v26, v27
    v_cvt_pk_bf16_f32 v46, v28, v29
    v_cvt_pk_bf16_f32 v47, v30, v31
    buffer_store_dwordx4 v[44:47], v234, s[36:39], s49 offen offset:3072 sc1
    s_waitcnt vmcnt(0)
    s_lshl3_add_u32 s45, s5, s3
    s_cmp_ge_u32 s45, 28
    s_barrier
    buffer_load_dword v237, v48, s[36:39], 0 offen sc1
    buffer_store_dword v50, v49, s[36:39], 0 offen sc1
    s_cbranch_scc1 L_done
    s_waitcnt vmcnt(1)
    v_cmp_gt_u32 vcc, v53, v237
    s_mov_b32 s51, 0
    s_cbranch_vccz L77
L74:
    buffer_load_dword v237, v48, s[36:39], 0 offen sc1
    s_add_u32 s51, s51, 1
    s_cmp_gt_u32 s51, 262144
    s_waitcnt vmcnt(0)
    v_cmp_gt_u32 vcc, v53, v237
    s_cbranch_scc1 L75
    s_cbranch_vccnz L74
L75:
L77:
    buffer_load_dwordx4 v[8:11], v55, s[36:39], s40 offen sc1
    s_add_u32 s40, s40, 524288
    buffer_load_dwordx4 v[12:15], v55, s[36:39], s40 offen sc1
    s_add_u32 s40, s40, 524288
    buffer_load_dwordx4 v[16:19], v55, s[36:39], s40 offen sc1
    s_add_u32 s40, s40, 524288
    buffer_load_dwordx4 v[20:23], v55, s[36:39], s40 offen sc1
    s_waitcnt vmcnt(3)
    v_lshlrev_b32 v0, 16, v8
    v_and_b32 v1, 0xffff0000, v8
    v_lshlrev_b32 v2, 16, v9
    v_and_b32 v3, 0xffff0000, v9
    v_lshlrev_b32 v4, 16, v10
    v_and_b32 v5, 0xffff0000, v10
    v_lshlrev_b32 v6, 16, v11
    v_and_b32 v7, 0xffff0000, v11
    s_waitcnt vmcnt(2)
    v_lshlrev_b32 v24, 16, v12
    v_and_b32 v25, 0xffff0000, v12
    v_lshlrev_b32 v26, 16, v13
    v_and_b32 v27, 0xffff0000, v13
    v_lshlrev_b32 v28, 16, v14
    v_and_b32 v29, 0xffff0000, v14
    v_lshlrev_b32 v30, 16, v15
    v_and_b32 v31, 0xffff0000, v15
    v_pk_add_f32 v[0:1], v[0:1], v[24:25]
    v_pk_add_f32 v[2:3], v[2:3], v[26:27]
    v_pk_add_f32 v[4:5], v[4:5], v[28:29]
    v_pk_add_f32 v[6:7], v[6:7], v[30:31]
    s_waitcnt vmcnt(1)
    v_lshlrev_b32 v24, 16, v16
    v_and_b32 v25, 0xffff0000, v16
    v_lshlrev_b32 v26, 16, v17
    v_and_b32 v27, 0xffff0000, v17
    v_lshlrev_b32 v28, 16, v18
    v_and_b32 v29, 0xffff0000, v18
    v_lshlrev_b32 v30, 16, v19
    v_and_b32 v31, 0xffff0000, v19
    v_pk_add_f32 v[0:1], v[0:1], v[24:25]
    v_pk_add_f32 v[2:3], v[2:3], v[26:27]
    v_pk_add_f32 v[4:5], v[4:5], v[28:29]
    v_pk_add_f32 v[6:7], v[6:7], v[30:31]
    s_waitcnt vmcnt(0)
    v_lshlrev_b32 v24, 16, v20
    v_and_b32 v25, 0xffff0000, v20
    v_lshlrev_b32 v26, 16, v21
    v_and_b32 v27, 0xffff0000, v21
    v_lshlrev_b32 v28, 16, v22
    v_and_b32 v29, 0xffff0000, v22
    v_lshlrev_b32 v30, 16, v23
    v_and_b32 v31, 0xffff0000, v23
    v_pk_add_f32 v[0:1], v[0:1], v[24:25]
    v_pk_add_f32 v[2:3], v[2:3], v[26:27]
    v_pk_add_f32 v[4:5], v[4:5], v[28:29]
    v_pk_add_f32 v[6:7], v[6:7], v[30:31]
    s_nop 0
    v_permlane32_swap_b32 v0, v4
    v_permlane32_swap_b32 v1, v5
    v_permlane32_swap_b32 v2, v6
    v_permlane32_swap_b32 v3, v7
    v_pk_add_f32 v[0:1], v[0:1], v[4:5]
    v_pk_add_f32 v[2:3], v[2:3], v[6:7]
    v_cvt_pk_bf16_f32 v8, v0, v1
    v_cvt_pk_bf16_f32 v9, v2, v3
    buffer_store_dwordx2 v[8:9], v51, s[28:31], s48 offen
    s_endpgm
L_done:
L_end:
    s_endpgm
L3:
L1:
    buffer_load_dword v237, v31, s[32:35], 0 offen sc1
    s_add_u32 s51, s51, 1
    s_cmp_gt_u32 s51, 262144
    s_waitcnt vmcnt(0)
    v_cmp_gt_u32 vcc, s46, v237
    s_cbranch_scc1 L2
    s_cbranch_vccnz L1
L2:
    s_branch L4
L11:
L9:
    buffer_load_dword v237, v31, s[32:35], 0 offen sc1
    s_add_u32 s51, s51, 1
    s_cmp_gt_u32 s51, 262144
    s_waitcnt vmcnt(0)
    v_cmp_gt_u32 vcc, s46, v237
    s_cbranch_scc1 L10
    s_cbranch_vccnz L9
L10:
    s_branch L12
L16:
    s_call_b64 s[92:93], L_lift
    s_branch L17
L18:
    s_call_b64 s[92:93], L_lift
    s_branch L19
L20:
    s_call_b64 s[92:93], L_lift
    s_branch L21
L22:
    s_call_b64 s[92:93], L_lift
    s_branch L23
L26:
L24:
    buffer_load_dword v237, v254, s[36:39], 0 offen sc1
    s_add_u32 s51, s51, 1
    s_cmp_gt_u32 s51, 262144
    s_waitcnt vmcnt(0)
    v_cmp_gt_u32 vcc, v250, v237
    s_cbranch_scc1 L25
    s_cbranch_vccnz L24
L25:
    s_branch L27
L28:
    buffer_store_dword v233, v235, s[36:39], 0 offen offset:4 sc1
    s_waitcnt vmcnt(0)
    s_branch L29
L30:
    buffer_wbl2 sc1
    s_waitcnt vmcnt(0)
    buffer_store_dword v232, v235, s[36:39], 0 offen sc1
    s_branch L31
L32:
    s_call_b64 s[92:93], L_lift
    s_branch L33
L34:
    s_call_b64 s[92:93], L_lift
    s_branch L35
L36:
    s_call_b64 s[92:93], L_lift
    s_branch L37
L40:
L38:
    buffer_load_dword v237, v236, s[36:39], 0 offen sc1
    s_add_u32 s51, s51, 1
    s_cmp_gt_u32 s51, 262144
    s_waitcnt vmcnt(0)
    v_cmp_gt_u32 vcc, 3, v237
    s_cbranch_scc1 L39
    s_cbranch_vccnz L38
L39:
    s_branch L41
L42:
    buffer_wbl2 sc1
    s_waitcnt vmcnt(0)
    buffer_store_dword v232, v235, s[36:39], 0 offen sc1
    s_branch L43
L48:
    buffer_inv sc1
    s_waitcnt vmcnt(0)
    s_branch L49
L50:
    buffer_wbl2 sc1
    s_waitcnt vmcnt(0)
    buffer_store_dword v232, v235, s[36:39], 0 offen sc1
    s_branch L51
L56:
    buffer_inv sc1
    s_waitcnt vmcnt(0)
    s_branch L57
L58:
    buffer_wbl2 sc1
    s_waitcnt vmcnt(0)
    buffer_store_dword v232, v235, s[36:39], 0 offen sc1
    s_branch L59
L64:
    buffer_inv sc1
    s_waitcnt vmcnt(0)
    s_branch L65
L66:
    buffer_wbl2 sc1
    s_waitcnt vmcnt(0)
    buffer_store_dword v232, v235, s[36:39], 0 offen sc1
    s_branch L67
L72:
    buffer_inv sc1
    s_waitcnt vmcnt(0)
    s_branch L73
L_lift:
    s_nop 7
    s_nop 7
    v_permlane32_swap_b32 v238, v239
    v_max_f32 v238, v238, v239
    v_mov_b32 v239, v238
    s_nop 1
    v_permlane16_swap_b32 v238, v239
    v_max_f32 v238, v238, v239
    v_mov_b32 v239, v238
    s_nop 1
    v_permlane32_swap_b32 v238, v239
    v_cmp_lt_f32 vcc, s50, v238
    s_nop 1
    v_cndmask_b32 v238, 0, v238, vcc
    v_add_f32 v228, v228, v238
    v_cmp_lt_f32 vcc, s50, v239
    s_nop 1
    v_cndmask_b32 v239, 0, v239, vcc
    v_add_f32 v229, v229, v239
    v_sub_f32 v242, 0, v228
    v_sub_f32 v243, 0, v228
    v_sub_f32 v244, 0, v228
    v_sub_f32 v245, 0, v228
    v_sub_f32 v246, 0, v229
    v_sub_f32 v247, 0, v229
    v_sub_f32 v248, 0, v229
    v_sub_f32 v249, 0, v229
    v_sub_f32 v16, v16, v238
    v_sub_f32 v17, v17, v238
    v_sub_f32 v18, v18, v238
    v_sub_f32 v19, v19, v238
    v_sub_f32 v20, v20, v238
    v_sub_f32 v21, v21, v238
    v_sub_f32 v22, v22, v238
    v_sub_f32 v23, v23, v238
    v_sub_f32 v24, v24, v239
    v_sub_f32 v25, v25, v239
    v_sub_f32 v26, v26, v239
    v_sub_f32 v27, v27, v239
    v_sub_f32 v28, v28, v239
    v_sub_f32 v29, v29, v239
    v_sub_f32 v30, v30, v239
    v_sub_f32 v31, v31, v239
    v_sub_f32 v32, v32, v238
    v_sub_f32 v33, v33, v238
    v_sub_f32 v34, v34, v238
    v_sub_f32 v35, v35, v238
    v_sub_f32 v36, v36, v238
    v_sub_f32 v37, v37, v238
    v_sub_f32 v38, v38, v238
    v_sub_f32 v39, v39, v238
    v_sub_f32 v40, v40, v239
    v_sub_f32 v41, v41, v239
    v_sub_f32 v42, v42, v239
    v_sub_f32 v43, v43, v239
    v_sub_f32 v44, v44, v239
    v_sub_f32 v45, v45, v239
    v_sub_f32 v46, v46, v239
    v_sub_f32 v47, v47, v239
    v_sub_f32 v48, v48, v238
    v_sub_f32 v49, v49, v238
    v_sub_f32 v50, v50, v238
    v_sub_f32 v51, v51, v238
    v_sub_f32 v52, v52, v238
    v_sub_f32 v53, v53, v238
    v_sub_f32 v54, v54, v238
    v_sub_f32 v55, v55, v238
    v_sub_f32 v56, v56, v239
    v_sub_f32 v57, v57, v239
    v_sub_f32 v58, v58, v239
    v_sub_f32 v59, v59, v239
    v_sub_f32 v60, v60, v239
    v_sub_f32 v61, v61, v239
    v_sub_f32 v62, v62, v239
    v_sub_f32 v63, v63, v239
    v_sub_f32 v64, v64, v238
    v_sub_f32 v65, v65, v238
    v_sub_f32 v66, v66, v238
    v_sub_f32 v67, v67, v238
    v_sub_f32 v68, v68, v238
    v_sub_f32 v69, v69, v238
    v_sub_f32 v70, v70, v238
    v_sub_f32 v71, v71, v238
    v_sub_f32 v72, v72, v239
    v_sub_f32 v73, v73, v239
    v_sub_f32 v74, v74, v239
    v_sub_f32 v75, v75, v239
    v_sub_f32 v76, v76, v239
    v_sub_f32 v77, v77, v239
    v_sub_f32 v78, v78, v239
    v_sub_f32 v79, v79, v239
    v_sub_f32 v80, v80, v238
    v_sub_f32 v81, v81, v238
    v_sub_f32 v82, v82, v238
    v_sub_f32 v83, v83, v238
    v_sub_f32 v84, v84, v238
    v_sub_f32 v85, v85, v238
    v_sub_f32 v86, v86, v238
    v_sub_f32 v87, v87, v238
    v_sub_f32 v88, v88, v239
    v_sub_f32 v89, v89, v239
    v_sub_f32 v90, v90, v239
    v_sub_f32 v91, v91, v239
    v_sub_f32 v92, v92, v239
    v_sub_f32 v93, v93, v239
    v_sub_f32 v94, v94, v239
    v_sub_f32 v95, v95, v239
    v_sub_f32 v96, v96, v238
    v_sub_f32 v97, v97, v238
    v_sub_f32 v98, v98, v238
    v_sub_f32 v99, v99, v238
    v_sub_f32 v100, v100, v238
    v_sub_f32 v101, v101, v238
    v_sub_f32 v102, v102, v238
    v_sub_f32 v103, v103, v238
    v_sub_f32 v104, v104, v239
    v_sub_f32 v105, v105, v239
    v_sub_f32 v106, v106, v239
    v_sub_f32 v107, v107, v239
    v_sub_f32 v108, v108, v239
    v_sub_f32 v109, v109, v239
    v_sub_f32 v110, v110, v239
    v_sub_f32 v111, v111, v239
    v_sub_f32 v112, v112, v238
    v_sub_f32 v113, v113, v238
    v_sub_f32 v114, v114, v238
    v_sub_f32 v115, v115, v238
    v_sub_f32 v116, v116, v238
    v_sub_f32 v117, v117, v238
    v_sub_f32 v118, v118, v238
    v_sub_f32 v119, v119, v238
    v_sub_f32 v120, v120, v239
    v_sub_f32 v121, v121, v239
    v_sub_f32 v122, v122, v239
    v_sub_f32 v123, v123, v239
    v_sub_f32 v124, v124, v239
    v_sub_f32 v125, v125, v239
    v_sub_f32 v126, v126, v239
    v_sub_f32 v127, v127, v239
    v_exp_f32 v238, -v238
    v_exp_f32 v239, -v239
    v_lshlrev_b32 v240, 16, v128
    v_and_b32 v241, 0xffff0000, v128
    v_mul_f32 v240, v238, v240
    v_mul_f32 v241, v238, v241
    v_cvt_pk_bf16_f32 v128, v240, v241
    v_lshlrev_b32 v240, 16, v129
    v_and_b32 v241, 0xffff0000, v129
    v_mul_f32 v240, v238, v240
    v_mul_f32 v241, v238, v241
    v_cvt_pk_bf16_f32 v129, v240, v241
    v_lshlrev_b32 v240, 16, v130
    v_and_b32 v241, 0xffff0000, v130
    v_mul_f32 v240, v238, v240
    v_mul_f32 v241, v238, v241
    v_cvt_pk_bf16_f32 v130, v240, v241
    v_lshlrev_b32 v240, 16, v131
    v_and_b32 v241, 0xffff0000, v131
    v_mul_f32 v240, v238, v240
    v_mul_f32 v241, v238, v241
    v_cvt_pk_bf16_f32 v131, v240, v241
    v_lshlrev_b32 v240, 16, v132
    v_and_b32 v241, 0xffff0000, v132
    v_mul_f32 v240, v239, v240
    v_mul_f32 v241, v239, v241
    v_cvt_pk_bf16_f32 v132, v240, v241
    v_lshlrev_b32 v240, 16, v133
    v_and_b32 v241, 0xffff0000, v133
    v_mul_f32 v240, v239, v240
    v_mul_f32 v241, v239, v241
    v_cvt_pk_bf16_f32 v133, v240, v241
    v_lshlrev_b32 v240, 16, v134
    v_and_b32 v241, 0xffff0000, v134
    v_mul_f32 v240, v239, v240
    v_mul_f32 v241, v239, v241
    v_cvt_pk_bf16_f32 v134, v240, v241
    v_lshlrev_b32 v240, 16, v135
    v_and_b32 v241, 0xffff0000, v135
    v_mul_f32 v240, v239, v240
    v_mul_f32 v241, v239, v241
    v_cvt_pk_bf16_f32 v135, v240, v241
    v_lshlrev_b32 v240, 16, v136
    v_and_b32 v241, 0xffff0000, v136
    v_mul_f32 v240, v238, v240
    v_mul_f32 v241, v238, v241
    v_cvt_pk_bf16_f32 v136, v240, v241
    v_lshlrev_b32 v240, 16, v137
    v_and_b32 v241, 0xffff0000, v137
    v_mul_f32 v240, v238, v240
    v_mul_f32 v241, v238, v241
    v_cvt_pk_bf16_f32 v137, v240, v241
    v_lshlrev_b32 v240, 16, v138
    v_and_b32 v241, 0xffff0000, v138
    v_mul_f32 v240, v238, v240
    v_mul_f32 v241, v238, v241
    v_cvt_pk_bf16_f32 v138, v240, v241
    v_lshlrev_b32 v240, 16, v139
    v_and_b32 v241, 0xffff0000, v139
    v_mul_f32 v240, v238, v240
    v_mul_f32 v241, v238, v241
    v_cvt_pk_bf16_f32 v139, v240, v241
    v_lshlrev_b32 v240, 16, v140
    v_and_b32 v241, 0xffff0000, v140
    v_mul_f32 v240, v239, v240
    v_mul_f32 v241, v239, v241
    v_cvt_pk_bf16_f32 v140, v240, v241
    v_lshlrev_b32 v240, 16, v141
    v_and_b32 v241, 0xffff0000, v141
    v_mul_f32 v240, v239, v240
    v_mul_f32 v241, v239, v241
    v_cvt_pk_bf16_f32 v141, v240, v241
    v_lshlrev_b32 v240, 16, v142
    v_and_b32 v241, 0xffff0000, v142
    v_mul_f32 v240, v239, v240
    v_mul_f32 v241, v239, v241
    v_cvt_pk_bf16_f32 v142, v240, v241
    v_lshlrev_b32 v240, 16, v143
    v_and_b32 v241, 0xffff0000, v143
    v_mul_f32 v240, v239, v240
    v_mul_f32 v241, v239, v241
    v_cvt_pk_bf16_f32 v143, v240, v241
    v_lshlrev_b32 v240, 16, v144
    v_and_b32 v241, 0xffff0000, v144
    v_mul_f32 v240, v238, v240
    v_mul_f32 v241, v238, v241
    v_cvt_pk_bf16_f32 v144, v240, v241
    v_lshlrev_b32 v240, 16, v145
    v_and_b32 v241, 0xffff0000, v145
    v_mul_f32 v240, v238, v240
    v_mul_f32 v241, v238, v241
    v_cvt_pk_bf16_f32 v145, v240, v241
    v_lshlrev_b32 v240, 16, v146
    v_and_b32 v241, 0xffff0000, v146
    v_mul_f32 v240, v238, v240
    v_mul_f32 v241, v238, v241
    v_cvt_pk_bf16_f32 v146, v240, v241
    v_lshlrev_b32 v240, 16, v147
    v_and_b32 v241, 0xffff0000, v147
    v_mul_f32 v240, v238, v240
    v_mul_f32 v241, v238, v241
    v_cvt_pk_bf16_f32 v147, v240, v241
    v_lshlrev_b32 v240, 16, v148
    v_and_b32 v241, 0xffff0000, v148
    v_mul_f32 v240, v239, v240
    v_mul_f32 v241, v239, v241
    v_cvt_pk_bf16_f32 v148, v240, v241
    v_lshlrev_b32 v240, 16, v149
    v_and_b32 v241, 0xffff0000, v149
    v_mul_f32 v240, v239, v240
    v_mul_f32 v241, v239, v241
    v_cvt_pk_bf16_f32 v149, v240, v241
    v_lshlrev_b32 v240, 16, v150
    v_and_b32 v241, 0xffff0000, v150
    v_mul_f32 v240, v239, v240
    v_mul_f32 v241, v239, v241
    v_cvt_pk_bf16_f32 v150, v240, v241
    v_lshlrev_b32 v240, 16, v151
    v_and_b32 v241, 0xffff0000, v151
    v_mul_f32 v240, v239, v240
    v_mul_f32 v241, v239, v241
    v_cvt_pk_bf16_f32 v151, v240, v241
    v_lshlrev_b32 v240, 16, v152
    v_and_b32 v241, 0xffff0000, v152
    v_mul_f32 v240, v238, v240
    v_mul_f32 v241, v238, v241
    v_cvt_pk_bf16_f32 v152, v240, v241
    v_lshlrev_b32 v240, 16, v153
    v_and_b32 v241, 0xffff0000, v153
    v_mul_f32 v240, v238, v240
    v_mul_f32 v241, v238, v241
    v_cvt_pk_bf16_f32 v153, v240, v241
    v_lshlrev_b32 v240, 16, v154
    v_and_b32 v241, 0xffff0000, v154
    v_mul_f32 v240, v238, v240
    v_mul_f32 v241, v238, v241
    v_cvt_pk_bf16_f32 v154, v240, v241
    v_lshlrev_b32 v240, 16, v155
    v_and_b32 v241, 0xffff0000, v155
    v_mul_f32 v240, v238, v240
    v_mul_f32 v241, v238, v241
    v_cvt_pk_bf16_f32 v155, v240, v241
    v_lshlrev_b32 v240, 16, v156
    v_and_b32 v241, 0xffff0000, v156
    v_mul_f32 v240, v239, v240
    v_mul_f32 v241, v239, v241
    v_cvt_pk_bf16_f32 v156, v240, v241
    v_lshlrev_b32 v240, 16, v157
    v_and_b32 v241, 0xffff0000, v157
    v_mul_f32 v240, v239, v240
    v_mul_f32 v241, v239, v241
    v_cvt_pk_bf16_f32 v157, v240, v241
    v_lshlrev_b32 v240, 16, v158
    v_and_b32 v241, 0xffff0000, v158
    v_mul_f32 v240, v239, v240
    v_mul_f32 v241, v239, v241
    v_cvt_pk_bf16_f32 v158, v240, v241
    v_lshlrev_b32 v240, 16, v159
    v_and_b32 v241, 0xffff0000, v159
    v_mul_f32 v240, v239, v240
    v_mul_f32 v241, v239, v241
    v_cvt_pk_bf16_f32 v159, v240, v241
    v_lshlrev_b32 v240, 16, v160
    v_and_b32 v241, 0xffff0000, v160
    v_mul_f32 v240, v238, v240
    v_mul_f32 v241, v238, v241
    v_cvt_pk_bf16_f32 v160, v240, v241
    v_lshlrev_b32 v240, 16, v161
    v_and_b32 v241, 0xffff0000, v161
    v_mul_f32 v240, v238, v240
    v_mul_f32 v241, v238, v241
    v_cvt_pk_bf16_f32 v161, v240, v241
    v_lshlrev_b32 v240, 16, v162
    v_and_b32 v241, 0xffff0000, v162
    v_mul_f32 v240, v238, v240
    v_mul_f32 v241, v238, v241
    v_cvt_pk_bf16_f32 v162, v240, v241
    v_lshlrev_b32 v240, 16, v163
    v_and_b32 v241, 0xffff0000, v163
    v_mul_f32 v240, v238, v240
    v_mul_f32 v241, v238, v241
    v_cvt_pk_bf16_f32 v163, v240, v241
    v_lshlrev_b32 v240, 16, v164
    v_and_b32 v241, 0xffff0000, v164
    v_mul_f32 v240, v239, v240
    v_mul_f32 v241, v239, v241
    v_cvt_pk_bf16_f32 v164, v240, v241
    v_lshlrev_b32 v240, 16, v165
    v_and_b32 v241, 0xffff0000, v165
    v_mul_f32 v240, v239, v240
    v_mul_f32 v241, v239, v241
    v_cvt_pk_bf16_f32 v165, v240, v241
    v_lshlrev_b32 v240, 16, v166
    v_and_b32 v241, 0xffff0000, v166
    v_mul_f32 v240, v239, v240
    v_mul_f32 v241, v239, v241
    v_cvt_pk_bf16_f32 v166, v240, v241
    v_lshlrev_b32 v240, 16, v167
    v_and_b32 v241, 0xffff0000, v167
    v_mul_f32 v240, v239, v240
    v_mul_f32 v241, v239, v241
    v_cvt_pk_bf16_f32 v167, v240, v241
    v_lshlrev_b32 v240, 16, v168
    v_and_b32 v241, 0xffff0000, v168
    v_mul_f32 v240, v238, v240
    v_mul_f32 v241, v238, v241
    v_cvt_pk_bf16_f32 v168, v240, v241
    v_lshlrev_b32 v240, 16, v169
    v_and_b32 v241, 0xffff0000, v169
    v_mul_f32 v240, v238, v240
    v_mul_f32 v241, v238, v241
    v_cvt_pk_bf16_f32 v169, v240, v241
    v_lshlrev_b32 v240, 16, v170
    v_and_b32 v241, 0xffff0000, v170
    v_mul_f32 v240, v238, v240
    v_mul_f32 v241, v238, v241
    v_cvt_pk_bf16_f32 v170, v240, v241
    v_lshlrev_b32 v240, 16, v171
    v_and_b32 v241, 0xffff0000, v171
    v_mul_f32 v240, v238, v240
    v_mul_f32 v241, v238, v241
    v_cvt_pk_bf16_f32 v171, v240, v241
    v_lshlrev_b32 v240, 16, v172
    v_and_b32 v241, 0xffff0000, v172
    v_mul_f32 v240, v239, v240
    v_mul_f32 v241, v239, v241
    v_cvt_pk_bf16_f32 v172, v240, v241
    v_lshlrev_b32 v240, 16, v173
    v_and_b32 v241, 0xffff0000, v173
    v_mul_f32 v240, v239, v240
    v_mul_f32 v241, v239, v241
    v_cvt_pk_bf16_f32 v173, v240, v241
    v_lshlrev_b32 v240, 16, v174
    v_and_b32 v241, 0xffff0000, v174
    v_mul_f32 v240, v239, v240
    v_mul_f32 v241, v239, v241
    v_cvt_pk_bf16_f32 v174, v240, v241
    v_lshlrev_b32 v240, 16, v175
    v_and_b32 v241, 0xffff0000, v175
    v_mul_f32 v240, v239, v240
    v_mul_f32 v241, v239, v241
    v_cvt_pk_bf16_f32 v175, v240, v241
    v_lshlrev_b32 v240, 16, v176
    v_and_b32 v241, 0xffff0000, v176
    v_mul_f32 v240, v238, v240
    v_mul_f32 v241, v238, v241
    v_cvt_pk_bf16_f32 v176, v240, v241
    v_lshlrev_b32 v240, 16, v177
    v_and_b32 v241, 0xffff0000, v177
    v_mul_f32 v240, v238, v240
    v_mul_f32 v241, v238, v241
    v_cvt_pk_bf16_f32 v177, v240, v241
    v_lshlrev_b32 v240, 16, v178
    v_and_b32 v241, 0xffff0000, v178
    v_mul_f32 v240, v238, v240
    v_mul_f32 v241, v238, v241
    v_cvt_pk_bf16_f32 v178, v240, v241
    v_lshlrev_b32 v240, 16, v179
    v_and_b32 v241, 0xffff0000, v179
    v_mul_f32 v240, v238, v240
    v_mul_f32 v241, v238, v241
    v_cvt_pk_bf16_f32 v179, v240, v241
    v_lshlrev_b32 v240, 16, v180
    v_and_b32 v241, 0xffff0000, v180
    v_mul_f32 v240, v239, v240
    v_mul_f32 v241, v239, v241
    v_cvt_pk_bf16_f32 v180, v240, v241
    v_lshlrev_b32 v240, 16, v181
    v_and_b32 v241, 0xffff0000, v181
    v_mul_f32 v240, v239, v240
    v_mul_f32 v241, v239, v241
    v_cvt_pk_bf16_f32 v181, v240, v241
    v_lshlrev_b32 v240, 16, v182
    v_and_b32 v241, 0xffff0000, v182
    v_mul_f32 v240, v239, v240
    v_mul_f32 v241, v239, v241
    v_cvt_pk_bf16_f32 v182, v240, v241
    v_lshlrev_b32 v240, 16, v183
    v_and_b32 v241, 0xffff0000, v183
    v_mul_f32 v240, v239, v240
    v_mul_f32 v241, v239, v241
    v_cvt_pk_bf16_f32 v183, v240, v241
    s_nop 3
    s_setpc_b64 s[92:93]
.fill (standalone__gqa_block_cached__near_ridge_kernel + 36864 - .) / 4, 4, 0xbf810000
.p2align 12, 0
.section .rodata,"a"
.p2align 6
.amdhsa_kernel standalone__gqa_block_cached__near_ridge_kernel
  .amdhsa_next_free_vgpr 512
  .amdhsa_next_free_sgpr 102
  .amdhsa_accum_offset 256
  .amdhsa_group_segment_fixed_size 0
  .amdhsa_kernarg_size 64
  .amdhsa_user_sgpr_count 2
  .amdhsa_user_sgpr_kernarg_segment_ptr 1
  .amdhsa_system_sgpr_workgroup_id_x 1
.end_amdhsa_kernel
```
